```python
import torch

def _softmax(x, axis=-1):
    return torch.softmax(x, dim=axis)
def _gelu(x):
    return torch.nn.functional.gelu(x, approximate="tanh")
def _silu(x):
    return torch.nn.functional.silu(x)
def _sigmoid(x):
    return torch.sigmoid(x)
def _layernorm(x, axis=-1, eps=1e-5):
    m = x.mean(dim=axis, keepdim=True)
    v = x.var(dim=axis, keepdim=True, unbiased=False)
    return (x - m) / torch.sqrt(v + eps)
def _scatter_add(tgt, idx, src, axis=0):
    return tgt.clone().index_add_(axis, idx, src)
def _segment_sum(src, seg, n):
    out = torch.zeros((n,) + src.shape[1:], dtype=src.dtype)
    return out.index_add_(0, seg, src)
def _pad(x, pw):
    flat = tuple(v for pair in reversed(pw) for v in pair)
    return torch.nn.functional.pad(x, flat)

kernel_name = 'parallel_sum__mha_block__glu_gated_bilinear__prompt'

def setup_inputs():

    _w = (lambda a: (lambda t: t.to(torch.bfloat16) if t.is_floating_point() else t)(torch.as_tensor(a)))
    def _A_setup():
        B, S, D, H = 1, 2048, 640, 32
        return {
            "x": _w((lambda *s: torch.randn(*s, dtype=torch.bfloat16) * 0.05)(B, S, D)),
            "wqkv": _w((lambda *s: torch.randn(*s, dtype=torch.bfloat16) * 0.05)(D, 3 * D)),
            "wo": _w((lambda *s: torch.randn(*s, dtype=torch.bfloat16) * 0.05)(D, D)),
        }
    _A_in = _A_setup()

    def _B_setup():
        B, S, D, F = 1, 2048, 640, 1728
        return {
            "x": _w((lambda *s: torch.randn(*s, dtype=torch.bfloat16) * 0.05)(B, S, D)),
            "w_gate": _w((lambda *s: torch.randn(*s, dtype=torch.bfloat16) * 0.8)(D, F) * (D ** -0.5)),
            "w_up": _w((lambda *s: torch.randn(*s, dtype=torch.bfloat16) * 0.8)(D, F) * (D ** -0.5)),
            "w_down": _w((lambda *s: torch.randn(*s, dtype=torch.bfloat16) * 0.8)(F, D) * (F ** -0.5)),
        }
    _B_in = _B_setup()

    return {
        "A_x": _A_in["x"],
        "A_wqkv": _A_in["wqkv"],
        "A_wo": _A_in["wo"],
        "B_x": _B_in["x"],
        "B_w_gate": _B_in["w_gate"],
        "B_w_up": _B_in["w_up"],
        "B_w_down": _B_in["w_down"],
    }

def reference(A_x, A_wqkv, A_wo, B_x, B_w_gate, B_w_up, B_w_down):
    def _A_ref(x, wqkv, wo):
        B, S, D = x.shape
        H = 32
        Dh = D // H
        qkv = (lambda x, *d: x.permute(*d))((x @ wqkv).reshape(B, S, 3, H, Dh), 2, 0, 3, 1, 4)
        q, k, v = qkv[0], qkv[1], qkv[2]
        scores = torch.einsum("bhqd,bhkd->bhqk", q, k) * (Dh ** -0.5)
        p = _softmax(scores, axis=-1)
        o = torch.einsum("bhqk,bhkd->bhqd", p, v)
        return (lambda x, *d: x.permute(*d))(o, 0, 2, 1, 3).reshape(B, S, D) @ wo

    def _B_ref(x, w_gate, w_up, w_down):
        g = torch.einsum("bsd,df->bsf", x, w_gate)
        u = torch.einsum("bsd,df->bsf", x, w_up)
        h = g * u
        return torch.einsum("bsf,fd->bsd", h, w_down)

    x = A_x
    xn = _layernorm(x, axis=-1)
    return x + _A_ref(xn, A_wqkv, A_wo) + _B_ref(xn, B_w_gate, B_w_up, B_w_down)
```

```asm
; @launch kernel=parallel_sum__mha_block__glu_gated_bilinear__prompt_kernel grid=(256,1,1) block=(512,1,1) lds=162816
; @launch kernel=attn_kernel grid=(256,1,1) block=(768,1,1) lds=144640
; @launch kernel=outp_kernel grid=(256,1,1) block=(256,1,1) lds=83968
.amdgcn_target "amdgcn-amd-amdhsa--gfx950"
.text
.globl parallel_sum__mha_block__glu_gated_bilinear__prompt_kernel
.p2align 8
.type parallel_sum__mha_block__glu_gated_bilinear__prompt_kernel,@function
parallel_sum__mha_block__glu_gated_bilinear__prompt_kernel:
    s_cmp_ge_u32 s2, 256
    s_cbranch_scc1 L_parallel_sum__mha_block__glu_gated_bilinear__prompt_kernel_end
    s_load_dwordx4 s[68:71], s[0:1], 0
    s_load_dwordx2 s[72:73], s[0:1], 16
    s_load_dwordx4 s[76:79], s[0:1], 32
    s_load_dwordx2 s[80:81], s[0:1], 48
    s_load_dwordx2 s[82:83], s[0:1], 72
    s_load_dwordx2 s[84:85], s[0:1], 64
    v_and_b32 v1, 63, v0
    v_lshrrev_b32 v2, 6, v0
    s_and_b32 s3, s2, 7
    s_lshr_b32 s4, s2, 3
    s_lshr_b32 s5, s3, 2
    s_lshl_b32 s5, s5, 2
    s_and_b32 s6, s4, 3
    s_add_u32 s20, s5, s6
    s_and_b32 s5, s3, 3
    s_lshl_b32 s5, s5, 3
    s_lshr_b32 s6, s4, 2
    s_add_u32 s21, s5, s6
    v_readfirstlane_b32 s22, v2
    s_waitcnt lgkmcnt(0)
    s_mov_b32 s16, s82
    s_mov_b32 s17, s83
    s_mov_b32 s18, 26099712
    s_mov_b32 s19, 0x20000
    s_cmp_ge_u32 s21, 30
    s_cbranch_scc1 L_parallel_sum__mha_block__glu_gated_bilinear__prompt_kernel_relay
    s_cmp_ge_u32 s22, 4
    s_cbranch_scc1 L_parallel_sum__mha_block__glu_gated_bilinear__prompt_kernel_prod
    s_cmp_ge_u32 s21, 12
    s_cbranch_scc1 L_parallel_sum__mha_block__glu_gated_bilinear__prompt_kernel_glu
    s_cmp_ge_u32 s21, 8
    s_cbranch_scc1 L_parallel_sum__mha_block__glu_gated_bilinear__prompt_kernel_v
    v_and_b32 v2, 31, v1
    v_lshrrev_b32 v3, 5, v1
    s_lshl_b32 s23, s22, 6
    v_add_u32 v21, s23, v2
    v_lshlrev_b32 v21, 7, v21
    v_bfe_u32 v22, v1, 1, 3
    v_xor_b32 v23, v3, v22
    v_lshlrev_b32 v23, 4, v23
    v_add_u32 v4, v21, v23
    v_add_u32 v4, 3072, v4
    v_xor_b32 v5, 32, v4
    v_xor_b32 v6, 64, v4
    v_xor_b32 v7, 96, v4
    v_bfe_u32 v21, v1, 2, 2
    v_lshlrev_b32 v22, 3, v3
    v_add_u32 v21, v21, v22
    v_mul_u32_u24 v21, 320, v21
    v_bfe_u32 v22, v1, 4, 1
    v_lshlrev_b32 v22, 5, v22
    v_and_b32 v23, 3, v1
    v_lshlrev_b32 v23, 3, v23
    v_add_u32 v21, v21, v22
    v_add_u32 v20, v21, v23
    v_add_u32 v20, 101376, v20
    v_mov_b32 v96, 0
    v_mov_b32 v97, 0
    v_mov_b32 v98, 0
    v_mov_b32 v99, 0
    v_mov_b32 v100, 0
    v_mov_b32 v101, 0
    v_mov_b32 v102, 0
    v_mov_b32 v103, 0
    v_mov_b32 v104, 0
    v_mov_b32 v105, 0
    v_mov_b32 v106, 0
    v_mov_b32 v107, 0
    v_mov_b32 v108, 0
    v_mov_b32 v109, 0
    v_mov_b32 v110, 0
    v_mov_b32 v111, 0
    v_mov_b32 v112, 0
    v_mov_b32 v113, 0
    v_mov_b32 v114, 0
    v_mov_b32 v115, 0
    v_mov_b32 v116, 0
    v_mov_b32 v117, 0
    v_mov_b32 v118, 0
    v_mov_b32 v119, 0
    v_mov_b32 v120, 0
    v_mov_b32 v121, 0
    v_mov_b32 v122, 0
    v_mov_b32 v123, 0
    v_mov_b32 v124, 0
    v_mov_b32 v125, 0
    v_mov_b32 v126, 0
    v_mov_b32 v127, 0
    v_mov_b32 v128, 0
    v_mov_b32 v129, 0
    v_mov_b32 v130, 0
    v_mov_b32 v131, 0
    v_mov_b32 v132, 0
    v_mov_b32 v133, 0
    v_mov_b32 v134, 0
    v_mov_b32 v135, 0
    v_mov_b32 v136, 0
    v_mov_b32 v137, 0
    v_mov_b32 v138, 0
    v_mov_b32 v139, 0
    v_mov_b32 v140, 0
    v_mov_b32 v141, 0
    v_mov_b32 v142, 0
    v_mov_b32 v143, 0
    v_mov_b32 v144, 0
    v_mov_b32 v145, 0
    v_mov_b32 v146, 0
    v_mov_b32 v147, 0
    v_mov_b32 v148, 0
    v_mov_b32 v149, 0
    v_mov_b32 v150, 0
    v_mov_b32 v151, 0
    v_mov_b32 v152, 0
    v_mov_b32 v153, 0
    v_mov_b32 v154, 0
    v_mov_b32 v155, 0
    v_mov_b32 v156, 0
    v_mov_b32 v157, 0
    v_mov_b32 v158, 0
    v_mov_b32 v159, 0
    v_mov_b32 v160, 0
    v_mov_b32 v161, 0
    v_mov_b32 v162, 0
    v_mov_b32 v163, 0
    v_mov_b32 v164, 0
    v_mov_b32 v165, 0
    v_mov_b32 v166, 0
    v_mov_b32 v167, 0
    v_mov_b32 v168, 0
    v_mov_b32 v169, 0
    v_mov_b32 v170, 0
    v_mov_b32 v171, 0
    v_mov_b32 v172, 0
    v_mov_b32 v173, 0
    v_mov_b32 v174, 0
    v_mov_b32 v175, 0
    v_mov_b32 v176, 0
    v_mov_b32 v177, 0
    v_mov_b32 v178, 0
    v_mov_b32 v179, 0
    v_mov_b32 v180, 0
    v_mov_b32 v181, 0
    v_mov_b32 v182, 0
    v_mov_b32 v183, 0
    v_mov_b32 v184, 0
    v_mov_b32 v185, 0
    v_mov_b32 v186, 0
    v_mov_b32 v187, 0
    v_mov_b32 v188, 0
    v_mov_b32 v189, 0
    v_mov_b32 v190, 0
    v_mov_b32 v191, 0
    v_mov_b32 v192, 0
    v_mov_b32 v193, 0
    v_mov_b32 v194, 0
    v_mov_b32 v195, 0
    v_mov_b32 v196, 0
    v_mov_b32 v197, 0
    v_mov_b32 v198, 0
    v_mov_b32 v199, 0
    v_mov_b32 v200, 0
    v_mov_b32 v201, 0
    v_mov_b32 v202, 0
    v_mov_b32 v203, 0
    v_mov_b32 v204, 0
    v_mov_b32 v205, 0
    v_mov_b32 v206, 0
    v_mov_b32 v207, 0
    v_mov_b32 v208, 0
    v_mov_b32 v209, 0
    v_mov_b32 v210, 0
    v_mov_b32 v211, 0
    v_mov_b32 v212, 0
    v_mov_b32 v213, 0
    v_mov_b32 v214, 0
    v_mov_b32 v215, 0
    v_mov_b32 v216, 0
    v_mov_b32 v217, 0
    v_mov_b32 v218, 0
    v_mov_b32 v219, 0
    v_mov_b32 v220, 0
    v_mov_b32 v221, 0
    v_mov_b32 v222, 0
    v_mov_b32 v223, 0
    v_mov_b32 v224, 0
    v_mov_b32 v225, 0
    v_mov_b32 v226, 0
    v_mov_b32 v227, 0
    v_mov_b32 v228, 0
    v_mov_b32 v229, 0
    v_mov_b32 v230, 0
    v_mov_b32 v231, 0
    v_mov_b32 v232, 0
    v_mov_b32 v233, 0
    v_mov_b32 v234, 0
    v_mov_b32 v235, 0
    v_mov_b32 v236, 0
    v_mov_b32 v237, 0
    v_mov_b32 v238, 0
    v_mov_b32 v239, 0
    v_mov_b32 v240, 0
    v_mov_b32 v241, 0
    v_mov_b32 v242, 0
    v_mov_b32 v243, 0
    v_mov_b32 v244, 0
    v_mov_b32 v245, 0
    v_mov_b32 v246, 0
    v_mov_b32 v247, 0
    v_mov_b32 v248, 0
    v_mov_b32 v249, 0
    v_mov_b32 v250, 0
    v_mov_b32 v251, 0
    v_mov_b32 v252, 0
    v_mov_b32 v253, 0
    v_mov_b32 v254, 0
    v_mov_b32 v255, 0
    v_cmp_gt_u32 vcc, 32, v1
    v_mov_b32 v10, 0x7ffffff0
    s_cmp_lg_u32 s22, 0
    s_cbranch_scc1 L_parallel_sum__mha_block__glu_gated_bilinear__prompt_kernel_qk_pfw
    s_mul_i32 s56, s20, 327680
    s_add_u32 s52, s68, s56
    s_addc_u32 s53, s69, 0
    s_mov_b32 s54, 327680
    s_and_b32 s56, s21, 7
    s_lshl_b32 s56, s56, 5
    v_add_u32 v8, s56, v2
    v_mul_u32_u24 v8, 1280, v8
    s_mov_b32 s57, 128
    s_mov_b32 s58, 1280
    s_branch L_parallel_sum__mha_block__glu_gated_bilinear__prompt_kernel_qk_pfd
L_parallel_sum__mha_block__glu_gated_bilinear__prompt_kernel_qk_pfw:
    s_mov_b32 s52, s70
    s_mov_b32 s53, s71
    s_mul_i32 s56, s21, 320
    s_and_b32 s56, s56, 0xffffff80
    s_cmp_eq_u32 s22, 2
    s_cselect_b32 s57, 256, 0
    s_add_u32 s56, s56, s57
    s_mov_b32 s54, 2457600
    s_cmp_eq_u32 s22, 3
    s_cselect_b32 s54, 0, s54
    s_and_b32 s57, s20, 3
    s_mul_i32 s57, s57, 61440
    s_add_u32 s56, s56, s57
    v_lshrrev_b32 v8, 1, v1
    v_mul_u32_u24 v8, 3840, v8
    v_and_b32 v9, 1, v1
    v_lshlrev_b32 v9, 7, v9
    v_add3_u32 v8, v8, v9, s56
    s_mov_b32 s57, 245760
    s_mov_b32 s58, 0x7fffffff
L_parallel_sum__mha_block__glu_gated_bilinear__prompt_kernel_qk_pfd:
    v_cndmask_b32 v8, v10, v8, vcc
    s_mov_b32 s55, 0x20000
    s_mul_i32 s56, s57, 2
    buffer_load_dword v9, v8, s[52:55], s56 offen
    s_add_u32 s56, s56, s57
    buffer_load_dword v9, v8, s[52:55], s56 offen
    s_add_u32 s56, s56, s57
    s_barrier
    ds_read_b128 v[32:35], v4 offset:0
    ds_read_b128 v[36:39], v4 offset:4096
    ds_read_b64_tr_b16 v[48:49], v20 offset:0
    ds_read_b64_tr_b16 v[50:51], v20 offset:1280
    ds_read_b64_tr_b16 v[52:53], v20 offset:64
    ds_read_b64_tr_b16 v[54:55], v20 offset:1344
    ds_read_b64_tr_b16 v[56:57], v20 offset:128
    ds_read_b64_tr_b16 v[58:59], v20 offset:1408
    ds_read_b64_tr_b16 v[60:61], v20 offset:192
    ds_read_b64_tr_b16 v[62:63], v20 offset:1472
    s_mov_b32 s24, 0
    s_mov_b32 s25, 0
    s_mov_b32 s27, 0
L_parallel_sum__mha_block__glu_gated_bilinear__prompt_kernel_qk_loop:
    s_waitcnt lgkmcnt(6)
    v_mfma_f32_32x32x16_bf16 v[96:111], v[48:51], v[32:35], v[96:111]
    ds_read_b64_tr_b16 v[64:65], v20 offset:256
    ds_read_b64_tr_b16 v[66:67], v20 offset:1536
    s_add_u32 s25, s25, 1
    s_cmp_eq_u32 s25, 5
    s_cselect_b32 s25, 0, s25
    s_mov_b32 s26, 12288
    s_cselect_b32 s26, 4294918144, s26
    v_mfma_f32_32x32x16_bf16 v[176:191], v[48:51], v[36:39], v[176:191]
    s_add_u32 s27, s27, 1
    s_cmp_eq_u32 s27, 3
    s_cselect_b32 s27, 0, s27
    s_mov_b32 s28, 32768
    s_cselect_b32 s28, 4294901760, s28
    s_waitcnt lgkmcnt(6)
    v_mfma_f32_32x32x16_bf16 v[112:127], v[52:55], v[32:35], v[112:127]
    ds_read_b64_tr_b16 v[48:49], v20 offset:5120
    ds_read_b64_tr_b16 v[50:51], v20 offset:6400
    v_mfma_f32_32x32x16_bf16 v[192:207], v[52:55], v[36:39], v[192:207]
    ds_read_b128 v[40:43], v5 offset:0
    ds_read_b128 v[44:47], v5 offset:4096
    s_waitcnt lgkmcnt(8)
    v_mfma_f32_32x32x16_bf16 v[128:143], v[56:59], v[32:35], v[128:143]
    ds_read_b64_tr_b16 v[52:53], v20 offset:5184
    ds_read_b64_tr_b16 v[54:55], v20 offset:6464
    v_mfma_f32_32x32x16_bf16 v[208:223], v[56:59], v[36:39], v[208:223]
    v_add_u32 v4, s28, v4
    s_waitcnt lgkmcnt(8)
    v_mfma_f32_32x32x16_bf16 v[144:159], v[60:63], v[32:35], v[144:159]
    ds_read_b64_tr_b16 v[56:57], v20 offset:5248
    ds_read_b64_tr_b16 v[58:59], v20 offset:6528
    v_mfma_f32_32x32x16_bf16 v[224:239], v[60:63], v[36:39], v[224:239]
    v_add_u32 v5, s28, v5
    s_waitcnt lgkmcnt(8)
    v_mfma_f32_32x32x16_bf16 v[160:175], v[64:67], v[32:35], v[160:175]
    ds_read_b64_tr_b16 v[60:61], v20 offset:5312
    ds_read_b64_tr_b16 v[62:63], v20 offset:6592
    s_cmp_lt_u32 s56, s58
    s_cselect_b32 s59, s56, 0x0ffffff0
    v_mfma_f32_32x32x16_bf16 v[240:255], v[64:67], v[36:39], v[240:255]
    buffer_load_dword v9, v8, s[52:55], s59 offen
    s_add_u32 s56, s56, s57
    s_waitcnt lgkmcnt(6)
    v_mfma_f32_32x32x16_bf16 v[96:111], v[48:51], v[40:43], v[96:111]
    ds_read_b64_tr_b16 v[64:65], v20 offset:5376
    ds_read_b64_tr_b16 v[66:67], v20 offset:6656
    v_mfma_f32_32x32x16_bf16 v[176:191], v[48:51], v[44:47], v[176:191]
    s_waitcnt lgkmcnt(6)
    v_mfma_f32_32x32x16_bf16 v[112:127], v[52:55], v[40:43], v[112:127]
    s_barrier
    v_add_u32 v20, s26, v20
    ds_read_b64_tr_b16 v[48:49], v20 offset:0
    ds_read_b64_tr_b16 v[50:51], v20 offset:1280
    v_mfma_f32_32x32x16_bf16 v[192:207], v[52:55], v[44:47], v[192:207]
    ds_read_b128 v[32:35], v6 offset:0
    ds_read_b128 v[36:39], v6 offset:4096
    s_waitcnt lgkmcnt(8)
    v_mfma_f32_32x32x16_bf16 v[128:143], v[56:59], v[40:43], v[128:143]
    ds_read_b64_tr_b16 v[52:53], v20 offset:64
    ds_read_b64_tr_b16 v[54:55], v20 offset:1344
    v_mfma_f32_32x32x16_bf16 v[208:223], v[56:59], v[44:47], v[208:223]
    s_waitcnt lgkmcnt(8)
    v_mfma_f32_32x32x16_bf16 v[144:159], v[60:63], v[40:43], v[144:159]
    ds_read_b64_tr_b16 v[56:57], v20 offset:128
    ds_read_b64_tr_b16 v[58:59], v20 offset:1408
    v_mfma_f32_32x32x16_bf16 v[224:239], v[60:63], v[44:47], v[224:239]
    s_waitcnt lgkmcnt(8)
    v_mfma_f32_32x32x16_bf16 v[160:175], v[64:67], v[40:43], v[160:175]
    ds_read_b64_tr_b16 v[60:61], v20 offset:192
    ds_read_b64_tr_b16 v[62:63], v20 offset:1472
    v_mfma_f32_32x32x16_bf16 v[240:255], v[64:67], v[44:47], v[240:255]
    s_waitcnt lgkmcnt(6)
    v_mfma_f32_32x32x16_bf16 v[96:111], v[48:51], v[32:35], v[96:111]
    ds_read_b64_tr_b16 v[64:65], v20 offset:256
    ds_read_b64_tr_b16 v[66:67], v20 offset:1536
    s_add_u32 s25, s25, 1
    s_cmp_eq_u32 s25, 5
    v_mfma_f32_32x32x16_bf16 v[176:191], v[48:51], v[36:39], v[176:191]
    s_cselect_b32 s25, 0, s25
    s_mov_b32 s26, 12288
    s_cselect_b32 s26, 4294918144, s26
    s_waitcnt lgkmcnt(6)
    v_mfma_f32_32x32x16_bf16 v[112:127], v[52:55], v[32:35], v[112:127]
    ds_read_b64_tr_b16 v[48:49], v20 offset:5120
    ds_read_b64_tr_b16 v[50:51], v20 offset:6400
    v_mfma_f32_32x32x16_bf16 v[192:207], v[52:55], v[36:39], v[192:207]
    ds_read_b128 v[40:43], v7 offset:0
    ds_read_b128 v[44:47], v7 offset:4096
    s_waitcnt lgkmcnt(8)
    v_mfma_f32_32x32x16_bf16 v[128:143], v[56:59], v[32:35], v[128:143]
    ds_read_b64_tr_b16 v[52:53], v20 offset:5184
    ds_read_b64_tr_b16 v[54:55], v20 offset:6464
    v_mfma_f32_32x32x16_bf16 v[208:223], v[56:59], v[36:39], v[208:223]
    v_add_u32 v6, s28, v6
    s_waitcnt lgkmcnt(8)
    v_mfma_f32_32x32x16_bf16 v[144:159], v[60:63], v[32:35], v[144:159]
    ds_read_b64_tr_b16 v[56:57], v20 offset:5248
    ds_read_b64_tr_b16 v[58:59], v20 offset:6528
    v_mfma_f32_32x32x16_bf16 v[224:239], v[60:63], v[36:39], v[224:239]
    v_add_u32 v7, s28, v7
    s_waitcnt lgkmcnt(8)
    v_mfma_f32_32x32x16_bf16 v[160:175], v[64:67], v[32:35], v[160:175]
    ds_read_b64_tr_b16 v[60:61], v20 offset:5312
    ds_read_b64_tr_b16 v[62:63], v20 offset:6592
    v_mfma_f32_32x32x16_bf16 v[240:255], v[64:67], v[36:39], v[240:255]
    s_waitcnt lgkmcnt(6)
    v_mfma_f32_32x32x16_bf16 v[96:111], v[48:51], v[40:43], v[96:111]
    ds_read_b64_tr_b16 v[64:65], v20 offset:5376
    ds_read_b64_tr_b16 v[66:67], v20 offset:6656
    v_mfma_f32_32x32x16_bf16 v[176:191], v[48:51], v[44:47], v[176:191]
    s_waitcnt lgkmcnt(6)
    v_mfma_f32_32x32x16_bf16 v[112:127], v[52:55], v[40:43], v[112:127]
    s_barrier
    v_add_u32 v20, s26, v20
    ds_read_b64_tr_b16 v[48:49], v20 offset:0
    ds_read_b64_tr_b16 v[50:51], v20 offset:1280
    v_mfma_f32_32x32x16_bf16 v[192:207], v[52:55], v[44:47], v[192:207]
    ds_read_b128 v[32:35], v4 offset:0
    ds_read_b128 v[36:39], v4 offset:4096
    s_waitcnt lgkmcnt(8)
    v_mfma_f32_32x32x16_bf16 v[128:143], v[56:59], v[40:43], v[128:143]
    ds_read_b64_tr_b16 v[52:53], v20 offset:64
    ds_read_b64_tr_b16 v[54:55], v20 offset:1344
    v_mfma_f32_32x32x16_bf16 v[208:223], v[56:59], v[44:47], v[208:223]
    s_waitcnt lgkmcnt(8)
    v_mfma_f32_32x32x16_bf16 v[144:159], v[60:63], v[40:43], v[144:159]
    ds_read_b64_tr_b16 v[56:57], v20 offset:128
    ds_read_b64_tr_b16 v[58:59], v20 offset:1408
    v_mfma_f32_32x32x16_bf16 v[224:239], v[60:63], v[44:47], v[224:239]
    s_waitcnt lgkmcnt(8)
    v_mfma_f32_32x32x16_bf16 v[160:175], v[64:67], v[40:43], v[160:175]
    ds_read_b64_tr_b16 v[60:61], v20 offset:192
    ds_read_b64_tr_b16 v[62:63], v20 offset:1472
    v_mfma_f32_32x32x16_bf16 v[240:255], v[64:67], v[44:47], v[240:255]
    s_add_u32 s24, s24, 1
    s_cmp_lt_u32 s24, 10
    s_cbranch_scc1 L_parallel_sum__mha_block__glu_gated_bilinear__prompt_kernel_qk_loop
    s_waitcnt vmcnt(0) lgkmcnt(0)
    s_nop 15
    v_add_u32 v10, s23, v2
    v_lshlrev_b32 v10, 2, v10
    ds_read_b32 v12, v10 offset:0
    ds_read_b32 v16, v10 offset:1024
    v_add_u32 v10, s23, v2
    v_lshlrev_b32 v10, 2, v10
    ds_read_b32 v14, v10 offset:128
    ds_read_b32 v18, v10 offset:1152
    v_lshlrev_b32 v11, 4, v3
    s_cmp_lt_u32 s21, 4
    s_cselect_b32 s30, 1051011932, 1.0
    s_mov_b32 s31, 163840
    s_mov_b32 s32, 2560
    s_mov_b32 s33, 2621440
    s_cselect_b32 s31, 81920, s31
    s_cselect_b32 s32, 1280, s32
    s_cselect_b32 s33, 0, s33
    s_and_b32 s34, s21, 3
    s_lshl_b32 s34, s34, 3
    s_mul_i32 s34, s34, s31
    s_add_u32 s33, s33, s34
    s_lshl_b32 s35, s20, 3
    s_lshl_b32 s36, s22, 1
    s_add_u32 s35, s35, s36
    s_mul_i32 s35, s35, s32
    s_add_u32 s33, s33, s35
    v_lshlrev_b32 v20, 4, v1
    v_lshlrev_b32 v21, 3, v2
    v_add_u32 v21, 1024, v21
    v_mul_lo_u32 v22, v3, s31
    v_add_u32 v21, v21, v22
    s_waitcnt lgkmcnt(0)
    v_sub_f32 v12, 0, v12
    v_sub_f32 v14, 0, v14
    v_mul_f32 v16, s30, v16
    v_mul_f32 v18, s30, v18
    ds_read_b128 v[32:35], v11 offset:2048
    ds_read_b128 v[36:39], v11 offset:2080
    ds_read_b128 v[40:43], v11 offset:2112
    ds_read_b128 v[44:47], v11 offset:2144
    s_waitcnt lgkmcnt(0)
    v_pk_fma_f32 v[96:97], v[32:33], v[12:13], v[96:97] op_sel_hi:[1,0,1]
    v_pk_fma_f32 v[98:99], v[34:35], v[12:13], v[98:99] op_sel_hi:[1,0,1]
    v_pk_fma_f32 v[100:101], v[36:37], v[12:13], v[100:101] op_sel_hi:[1,0,1]
    v_pk_fma_f32 v[102:103], v[38:39], v[12:13], v[102:103] op_sel_hi:[1,0,1]
    v_pk_fma_f32 v[104:105], v[40:41], v[12:13], v[104:105] op_sel_hi:[1,0,1]
    v_pk_fma_f32 v[106:107], v[42:43], v[12:13], v[106:107] op_sel_hi:[1,0,1]
    v_pk_fma_f32 v[108:109], v[44:45], v[12:13], v[108:109] op_sel_hi:[1,0,1]
    v_pk_fma_f32 v[110:111], v[46:47], v[12:13], v[110:111] op_sel_hi:[1,0,1]
    v_pk_mul_f32 v[96:97], v[96:97], v[16:17] op_sel_hi:[1,0]
    v_pk_mul_f32 v[98:99], v[98:99], v[16:17] op_sel_hi:[1,0]
    v_pk_mul_f32 v[100:101], v[100:101], v[16:17] op_sel_hi:[1,0]
    v_pk_mul_f32 v[102:103], v[102:103], v[16:17] op_sel_hi:[1,0]
    v_pk_mul_f32 v[104:105], v[104:105], v[16:17] op_sel_hi:[1,0]
    v_pk_mul_f32 v[106:107], v[106:107], v[16:17] op_sel_hi:[1,0]
    v_pk_mul_f32 v[108:109], v[108:109], v[16:17] op_sel_hi:[1,0]
    v_pk_mul_f32 v[110:111], v[110:111], v[16:17] op_sel_hi:[1,0]
    v_pk_fma_f32 v[176:177], v[32:33], v[14:15], v[176:177] op_sel_hi:[1,0,1]
    v_pk_fma_f32 v[178:179], v[34:35], v[14:15], v[178:179] op_sel_hi:[1,0,1]
    v_pk_fma_f32 v[180:181], v[36:37], v[14:15], v[180:181] op_sel_hi:[1,0,1]
    v_pk_fma_f32 v[182:183], v[38:39], v[14:15], v[182:183] op_sel_hi:[1,0,1]
    v_pk_fma_f32 v[184:185], v[40:41], v[14:15], v[184:185] op_sel_hi:[1,0,1]
    v_pk_fma_f32 v[186:187], v[42:43], v[14:15], v[186:187] op_sel_hi:[1,0,1]
    v_pk_fma_f32 v[188:189], v[44:45], v[14:15], v[188:189] op_sel_hi:[1,0,1]
    v_pk_fma_f32 v[190:191], v[46:47], v[14:15], v[190:191] op_sel_hi:[1,0,1]
    v_pk_mul_f32 v[176:177], v[176:177], v[18:19] op_sel_hi:[1,0]
    v_pk_mul_f32 v[178:179], v[178:179], v[18:19] op_sel_hi:[1,0]
    v_pk_mul_f32 v[180:181], v[180:181], v[18:19] op_sel_hi:[1,0]
    v_pk_mul_f32 v[182:183], v[182:183], v[18:19] op_sel_hi:[1,0]
    v_pk_mul_f32 v[184:185], v[184:185], v[18:19] op_sel_hi:[1,0]
    v_pk_mul_f32 v[186:187], v[186:187], v[18:19] op_sel_hi:[1,0]
    v_pk_mul_f32 v[188:189], v[188:189], v[18:19] op_sel_hi:[1,0]
    v_pk_mul_f32 v[190:191], v[190:191], v[18:19] op_sel_hi:[1,0]
    ds_read_b128 v[32:35], v11 offset:2176
    ds_read_b128 v[36:39], v11 offset:2208
    ds_read_b128 v[40:43], v11 offset:2240
    ds_read_b128 v[44:47], v11 offset:2272
    s_waitcnt lgkmcnt(0)
    v_pk_fma_f32 v[112:113], v[32:33], v[12:13], v[112:113] op_sel_hi:[1,0,1]
    v_pk_fma_f32 v[114:115], v[34:35], v[12:13], v[114:115] op_sel_hi:[1,0,1]
    v_pk_fma_f32 v[116:117], v[36:37], v[12:13], v[116:117] op_sel_hi:[1,0,1]
    v_pk_fma_f32 v[118:119], v[38:39], v[12:13], v[118:119] op_sel_hi:[1,0,1]
    v_pk_fma_f32 v[120:121], v[40:41], v[12:13], v[120:121] op_sel_hi:[1,0,1]
    v_pk_fma_f32 v[122:123], v[42:43], v[12:13], v[122:123] op_sel_hi:[1,0,1]
    v_pk_fma_f32 v[124:125], v[44:45], v[12:13], v[124:125] op_sel_hi:[1,0,1]
    v_pk_fma_f32 v[126:127], v[46:47], v[12:13], v[126:127] op_sel_hi:[1,0,1]
    v_pk_mul_f32 v[112:113], v[112:113], v[16:17] op_sel_hi:[1,0]
    v_pk_mul_f32 v[114:115], v[114:115], v[16:17] op_sel_hi:[1,0]
    v_pk_mul_f32 v[116:117], v[116:117], v[16:17] op_sel_hi:[1,0]
    v_pk_mul_f32 v[118:119], v[118:119], v[16:17] op_sel_hi:[1,0]
    v_pk_mul_f32 v[120:121], v[120:121], v[16:17] op_sel_hi:[1,0]
    v_pk_mul_f32 v[122:123], v[122:123], v[16:17] op_sel_hi:[1,0]
    v_pk_mul_f32 v[124:125], v[124:125], v[16:17] op_sel_hi:[1,0]
    v_pk_mul_f32 v[126:127], v[126:127], v[16:17] op_sel_hi:[1,0]
    v_pk_fma_f32 v[192:193], v[32:33], v[14:15], v[192:193] op_sel_hi:[1,0,1]
    v_pk_fma_f32 v[194:195], v[34:35], v[14:15], v[194:195] op_sel_hi:[1,0,1]
    v_pk_fma_f32 v[196:197], v[36:37], v[14:15], v[196:197] op_sel_hi:[1,0,1]
    v_pk_fma_f32 v[198:199], v[38:39], v[14:15], v[198:199] op_sel_hi:[1,0,1]
    v_pk_fma_f32 v[200:201], v[40:41], v[14:15], v[200:201] op_sel_hi:[1,0,1]
    v_pk_fma_f32 v[202:203], v[42:43], v[14:15], v[202:203] op_sel_hi:[1,0,1]
    v_pk_fma_f32 v[204:205], v[44:45], v[14:15], v[204:205] op_sel_hi:[1,0,1]
    v_pk_fma_f32 v[206:207], v[46:47], v[14:15], v[206:207] op_sel_hi:[1,0,1]
    v_pk_mul_f32 v[192:193], v[192:193], v[18:19] op_sel_hi:[1,0]
    v_pk_mul_f32 v[194:195], v[194:195], v[18:19] op_sel_hi:[1,0]
    v_pk_mul_f32 v[196:197], v[196:197], v[18:19] op_sel_hi:[1,0]
    v_pk_mul_f32 v[198:199], v[198:199], v[18:19] op_sel_hi:[1,0]
    v_pk_mul_f32 v[200:201], v[200:201], v[18:19] op_sel_hi:[1,0]
    v_pk_mul_f32 v[202:203], v[202:203], v[18:19] op_sel_hi:[1,0]
    v_pk_mul_f32 v[204:205], v[204:205], v[18:19] op_sel_hi:[1,0]
    v_pk_mul_f32 v[206:207], v[206:207], v[18:19] op_sel_hi:[1,0]
    ds_read_b128 v[32:35], v11 offset:2304
    ds_read_b128 v[36:39], v11 offset:2336
    ds_read_b128 v[40:43], v11 offset:2368
    ds_read_b128 v[44:47], v11 offset:2400
    s_waitcnt lgkmcnt(0)
    v_pk_fma_f32 v[128:129], v[32:33], v[12:13], v[128:129] op_sel_hi:[1,0,1]
    v_pk_fma_f32 v[130:131], v[34:35], v[12:13], v[130:131] op_sel_hi:[1,0,1]
    v_pk_fma_f32 v[132:133], v[36:37], v[12:13], v[132:133] op_sel_hi:[1,0,1]
    v_pk_fma_f32 v[134:135], v[38:39], v[12:13], v[134:135] op_sel_hi:[1,0,1]
    v_pk_fma_f32 v[136:137], v[40:41], v[12:13], v[136:137] op_sel_hi:[1,0,1]
    v_pk_fma_f32 v[138:139], v[42:43], v[12:13], v[138:139] op_sel_hi:[1,0,1]
    v_pk_fma_f32 v[140:141], v[44:45], v[12:13], v[140:141] op_sel_hi:[1,0,1]
    v_pk_fma_f32 v[142:143], v[46:47], v[12:13], v[142:143] op_sel_hi:[1,0,1]
    v_pk_mul_f32 v[128:129], v[128:129], v[16:17] op_sel_hi:[1,0]
    v_pk_mul_f32 v[130:131], v[130:131], v[16:17] op_sel_hi:[1,0]
    v_pk_mul_f32 v[132:133], v[132:133], v[16:17] op_sel_hi:[1,0]
    v_pk_mul_f32 v[134:135], v[134:135], v[16:17] op_sel_hi:[1,0]
    v_pk_mul_f32 v[136:137], v[136:137], v[16:17] op_sel_hi:[1,0]
    v_pk_mul_f32 v[138:139], v[138:139], v[16:17] op_sel_hi:[1,0]
    v_pk_mul_f32 v[140:141], v[140:141], v[16:17] op_sel_hi:[1,0]
    v_pk_mul_f32 v[142:143], v[142:143], v[16:17] op_sel_hi:[1,0]
    v_pk_fma_f32 v[208:209], v[32:33], v[14:15], v[208:209] op_sel_hi:[1,0,1]
    v_pk_fma_f32 v[210:211], v[34:35], v[14:15], v[210:211] op_sel_hi:[1,0,1]
    v_pk_fma_f32 v[212:213], v[36:37], v[14:15], v[212:213] op_sel_hi:[1,0,1]
    v_pk_fma_f32 v[214:215], v[38:39], v[14:15], v[214:215] op_sel_hi:[1,0,1]
    v_pk_fma_f32 v[216:217], v[40:41], v[14:15], v[216:217] op_sel_hi:[1,0,1]
    v_pk_fma_f32 v[218:219], v[42:43], v[14:15], v[218:219] op_sel_hi:[1,0,1]
    v_pk_fma_f32 v[220:221], v[44:45], v[14:15], v[220:221] op_sel_hi:[1,0,1]
    v_pk_fma_f32 v[222:223], v[46:47], v[14:15], v[222:223] op_sel_hi:[1,0,1]
    v_pk_mul_f32 v[208:209], v[208:209], v[18:19] op_sel_hi:[1,0]
    v_pk_mul_f32 v[210:211], v[210:211], v[18:19] op_sel_hi:[1,0]
    v_pk_mul_f32 v[212:213], v[212:213], v[18:19] op_sel_hi:[1,0]
    v_pk_mul_f32 v[214:215], v[214:215], v[18:19] op_sel_hi:[1,0]
    v_pk_mul_f32 v[216:217], v[216:217], v[18:19] op_sel_hi:[1,0]
    v_pk_mul_f32 v[218:219], v[218:219], v[18:19] op_sel_hi:[1,0]
    v_pk_mul_f32 v[220:221], v[220:221], v[18:19] op_sel_hi:[1,0]
    v_pk_mul_f32 v[222:223], v[222:223], v[18:19] op_sel_hi:[1,0]
    ds_read_b128 v[32:35], v11 offset:2432
    ds_read_b128 v[36:39], v11 offset:2464
    ds_read_b128 v[40:43], v11 offset:2496
    ds_read_b128 v[44:47], v11 offset:2528
    s_waitcnt lgkmcnt(0)
    v_pk_fma_f32 v[144:145], v[32:33], v[12:13], v[144:145] op_sel_hi:[1,0,1]
    v_pk_fma_f32 v[146:147], v[34:35], v[12:13], v[146:147] op_sel_hi:[1,0,1]
    v_pk_fma_f32 v[148:149], v[36:37], v[12:13], v[148:149] op_sel_hi:[1,0,1]
    v_pk_fma_f32 v[150:151], v[38:39], v[12:13], v[150:151] op_sel_hi:[1,0,1]
    v_pk_fma_f32 v[152:153], v[40:41], v[12:13], v[152:153] op_sel_hi:[1,0,1]
    v_pk_fma_f32 v[154:155], v[42:43], v[12:13], v[154:155] op_sel_hi:[1,0,1]
    v_pk_fma_f32 v[156:157], v[44:45], v[12:13], v[156:157] op_sel_hi:[1,0,1]
    v_pk_fma_f32 v[158:159], v[46:47], v[12:13], v[158:159] op_sel_hi:[1,0,1]
    v_pk_mul_f32 v[144:145], v[144:145], v[16:17] op_sel_hi:[1,0]
    v_pk_mul_f32 v[146:147], v[146:147], v[16:17] op_sel_hi:[1,0]
    v_pk_mul_f32 v[148:149], v[148:149], v[16:17] op_sel_hi:[1,0]
    v_pk_mul_f32 v[150:151], v[150:151], v[16:17] op_sel_hi:[1,0]
    v_pk_mul_f32 v[152:153], v[152:153], v[16:17] op_sel_hi:[1,0]
    v_pk_mul_f32 v[154:155], v[154:155], v[16:17] op_sel_hi:[1,0]
    v_pk_mul_f32 v[156:157], v[156:157], v[16:17] op_sel_hi:[1,0]
    v_pk_mul_f32 v[158:159], v[158:159], v[16:17] op_sel_hi:[1,0]
    v_pk_fma_f32 v[224:225], v[32:33], v[14:15], v[224:225] op_sel_hi:[1,0,1]
    v_pk_fma_f32 v[226:227], v[34:35], v[14:15], v[226:227] op_sel_hi:[1,0,1]
    v_pk_fma_f32 v[228:229], v[36:37], v[14:15], v[228:229] op_sel_hi:[1,0,1]
    v_pk_fma_f32 v[230:231], v[38:39], v[14:15], v[230:231] op_sel_hi:[1,0,1]
    v_pk_fma_f32 v[232:233], v[40:41], v[14:15], v[232:233] op_sel_hi:[1,0,1]
    v_pk_fma_f32 v[234:235], v[42:43], v[14:15], v[234:235] op_sel_hi:[1,0,1]
    v_pk_fma_f32 v[236:237], v[44:45], v[14:15], v[236:237] op_sel_hi:[1,0,1]
    v_pk_fma_f32 v[238:239], v[46:47], v[14:15], v[238:239] op_sel_hi:[1,0,1]
    v_pk_mul_f32 v[224:225], v[224:225], v[18:19] op_sel_hi:[1,0]
    v_pk_mul_f32 v[226:227], v[226:227], v[18:19] op_sel_hi:[1,0]
    v_pk_mul_f32 v[228:229], v[228:229], v[18:19] op_sel_hi:[1,0]
    v_pk_mul_f32 v[230:231], v[230:231], v[18:19] op_sel_hi:[1,0]
    v_pk_mul_f32 v[232:233], v[232:233], v[18:19] op_sel_hi:[1,0]
    v_pk_mul_f32 v[234:235], v[234:235], v[18:19] op_sel_hi:[1,0]
    v_pk_mul_f32 v[236:237], v[236:237], v[18:19] op_sel_hi:[1,0]
    v_pk_mul_f32 v[238:239], v[238:239], v[18:19] op_sel_hi:[1,0]
    ds_read_b128 v[32:35], v11 offset:2560
    ds_read_b128 v[36:39], v11 offset:2592
    ds_read_b128 v[40:43], v11 offset:2624
    ds_read_b128 v[44:47], v11 offset:2656
    s_waitcnt lgkmcnt(0)
    v_pk_fma_f32 v[160:161], v[32:33], v[12:13], v[160:161] op_sel_hi:[1,0,1]
    v_pk_fma_f32 v[162:163], v[34:35], v[12:13], v[162:163] op_sel_hi:[1,0,1]
    v_pk_fma_f32 v[164:165], v[36:37], v[12:13], v[164:165] op_sel_hi:[1,0,1]
    v_pk_fma_f32 v[166:167], v[38:39], v[12:13], v[166:167] op_sel_hi:[1,0,1]
    v_pk_fma_f32 v[168:169], v[40:41], v[12:13], v[168:169] op_sel_hi:[1,0,1]
    v_pk_fma_f32 v[170:171], v[42:43], v[12:13], v[170:171] op_sel_hi:[1,0,1]
    v_pk_fma_f32 v[172:173], v[44:45], v[12:13], v[172:173] op_sel_hi:[1,0,1]
    v_pk_fma_f32 v[174:175], v[46:47], v[12:13], v[174:175] op_sel_hi:[1,0,1]
    v_pk_mul_f32 v[160:161], v[160:161], v[16:17] op_sel_hi:[1,0]
    v_pk_mul_f32 v[162:163], v[162:163], v[16:17] op_sel_hi:[1,0]
    v_pk_mul_f32 v[164:165], v[164:165], v[16:17] op_sel_hi:[1,0]
    v_pk_mul_f32 v[166:167], v[166:167], v[16:17] op_sel_hi:[1,0]
    v_pk_mul_f32 v[168:169], v[168:169], v[16:17] op_sel_hi:[1,0]
    v_pk_mul_f32 v[170:171], v[170:171], v[16:17] op_sel_hi:[1,0]
    v_pk_mul_f32 v[172:173], v[172:173], v[16:17] op_sel_hi:[1,0]
    v_pk_mul_f32 v[174:175], v[174:175], v[16:17] op_sel_hi:[1,0]
    v_pk_fma_f32 v[240:241], v[32:33], v[14:15], v[240:241] op_sel_hi:[1,0,1]
    v_pk_fma_f32 v[242:243], v[34:35], v[14:15], v[242:243] op_sel_hi:[1,0,1]
    v_pk_fma_f32 v[244:245], v[36:37], v[14:15], v[244:245] op_sel_hi:[1,0,1]
    v_pk_fma_f32 v[246:247], v[38:39], v[14:15], v[246:247] op_sel_hi:[1,0,1]
    v_pk_fma_f32 v[248:249], v[40:41], v[14:15], v[248:249] op_sel_hi:[1,0,1]
    v_pk_fma_f32 v[250:251], v[42:43], v[14:15], v[250:251] op_sel_hi:[1,0,1]
    v_pk_fma_f32 v[252:253], v[44:45], v[14:15], v[252:253] op_sel_hi:[1,0,1]
    v_pk_fma_f32 v[254:255], v[46:47], v[14:15], v[254:255] op_sel_hi:[1,0,1]
    v_pk_mul_f32 v[240:241], v[240:241], v[18:19] op_sel_hi:[1,0]
    v_pk_mul_f32 v[242:243], v[242:243], v[18:19] op_sel_hi:[1,0]
    v_pk_mul_f32 v[244:245], v[244:245], v[18:19] op_sel_hi:[1,0]
    v_pk_mul_f32 v[246:247], v[246:247], v[18:19] op_sel_hi:[1,0]
    v_pk_mul_f32 v[248:249], v[248:249], v[18:19] op_sel_hi:[1,0]
    v_pk_mul_f32 v[250:251], v[250:251], v[18:19] op_sel_hi:[1,0]
    v_pk_mul_f32 v[252:253], v[252:253], v[18:19] op_sel_hi:[1,0]
    v_pk_mul_f32 v[254:255], v[254:255], v[18:19] op_sel_hi:[1,0]
    v_cvt_pk_bf16_f32 v48, v96, v97
    v_cvt_pk_bf16_f32 v49, v98, v99
    v_cvt_pk_bf16_f32 v50, v100, v101
    v_cvt_pk_bf16_f32 v51, v102, v103
    v_cvt_pk_bf16_f32 v52, v108, v109
    v_cvt_pk_bf16_f32 v53, v110, v111
    v_cvt_pk_bf16_f32 v54, v112, v113
    v_cvt_pk_bf16_f32 v55, v114, v115
    v_cvt_pk_bf16_f32 v56, v104, v105
    v_cvt_pk_bf16_f32 v57, v106, v107
    s_mul_i32 s36, s31, 0
    s_add_u32 s36, s36, s33
    s_mul_i32 s37, s32, 0
    s_add_u32 s36, s36, s37
    s_add_u32 s37, s36, s31
    buffer_store_dwordx4 v[48:51], v20, s[16:19], s36 offen sc0 sc1
    buffer_store_dwordx4 v[52:55], v20, s[16:19], s37 offen sc0 sc1
    buffer_store_dwordx2 v[56:57], v21, s[16:19], s36 offen sc0 sc1
    v_cvt_pk_bf16_f32 v60, v116, v117
    v_cvt_pk_bf16_f32 v61, v118, v119
    v_cvt_pk_bf16_f32 v62, v120, v121
    v_cvt_pk_bf16_f32 v63, v122, v123
    v_cvt_pk_bf16_f32 v64, v128, v129
    v_cvt_pk_bf16_f32 v65, v130, v131
    v_cvt_pk_bf16_f32 v66, v132, v133
    v_cvt_pk_bf16_f32 v67, v134, v135
    v_cvt_pk_bf16_f32 v68, v124, v125
    v_cvt_pk_bf16_f32 v69, v126, v127
    s_mul_i32 s36, s31, 2
    s_add_u32 s36, s36, s33
    s_mul_i32 s37, s32, 0
    s_add_u32 s36, s36, s37
    s_add_u32 s37, s36, s31
    buffer_store_dwordx4 v[60:63], v20, s[16:19], s36 offen sc0 sc1
    buffer_store_dwordx4 v[64:67], v20, s[16:19], s37 offen sc0 sc1
    buffer_store_dwordx2 v[68:69], v21, s[16:19], s36 offen sc0 sc1
    v_cvt_pk_bf16_f32 v72, v136, v137
    v_cvt_pk_bf16_f32 v73, v138, v139
    v_cvt_pk_bf16_f32 v74, v140, v141
    v_cvt_pk_bf16_f32 v75, v142, v143
    v_cvt_pk_bf16_f32 v76, v148, v149
    v_cvt_pk_bf16_f32 v77, v150, v151
    v_cvt_pk_bf16_f32 v78, v152, v153
    v_cvt_pk_bf16_f32 v79, v154, v155
    v_cvt_pk_bf16_f32 v80, v144, v145
    v_cvt_pk_bf16_f32 v81, v146, v147
    s_mul_i32 s36, s31, 4
    s_add_u32 s36, s36, s33
    s_mul_i32 s37, s32, 0
    s_add_u32 s36, s36, s37
    s_add_u32 s37, s36, s31
    buffer_store_dwordx4 v[72:75], v20, s[16:19], s36 offen sc0 sc1
    buffer_store_dwordx4 v[76:79], v20, s[16:19], s37 offen sc0 sc1
    buffer_store_dwordx2 v[80:81], v21, s[16:19], s36 offen sc0 sc1
    v_cvt_pk_bf16_f32 v48, v156, v157
    v_cvt_pk_bf16_f32 v49, v158, v159
    v_cvt_pk_bf16_f32 v50, v160, v161
    v_cvt_pk_bf16_f32 v51, v162, v163
    v_cvt_pk_bf16_f32 v52, v168, v169
    v_cvt_pk_bf16_f32 v53, v170, v171
    v_cvt_pk_bf16_f32 v54, v172, v173
    v_cvt_pk_bf16_f32 v55, v174, v175
    v_cvt_pk_bf16_f32 v56, v164, v165
    v_cvt_pk_bf16_f32 v57, v166, v167
    s_mul_i32 s36, s31, 6
    s_add_u32 s36, s36, s33
    s_mul_i32 s37, s32, 0
    s_add_u32 s36, s36, s37
    s_add_u32 s37, s36, s31
    buffer_store_dwordx4 v[48:51], v20, s[16:19], s36 offen sc0 sc1
    buffer_store_dwordx4 v[52:55], v20, s[16:19], s37 offen sc0 sc1
    buffer_store_dwordx2 v[56:57], v21, s[16:19], s36 offen sc0 sc1
    v_cvt_pk_bf16_f32 v60, v176, v177
    v_cvt_pk_bf16_f32 v61, v178, v179
    v_cvt_pk_bf16_f32 v62, v180, v181
    v_cvt_pk_bf16_f32 v63, v182, v183
    v_cvt_pk_bf16_f32 v64, v188, v189
    v_cvt_pk_bf16_f32 v65, v190, v191
    v_cvt_pk_bf16_f32 v66, v192, v193
    v_cvt_pk_bf16_f32 v67, v194, v195
    v_cvt_pk_bf16_f32 v68, v184, v185
    v_cvt_pk_bf16_f32 v69, v186, v187
    s_mul_i32 s36, s31, 0
    s_add_u32 s36, s36, s33
    s_mul_i32 s37, s32, 1
    s_add_u32 s36, s36, s37
    s_add_u32 s37, s36, s31
    buffer_store_dwordx4 v[60:63], v20, s[16:19], s36 offen sc0 sc1
    buffer_store_dwordx4 v[64:67], v20, s[16:19], s37 offen sc0 sc1
    buffer_store_dwordx2 v[68:69], v21, s[16:19], s36 offen sc0 sc1
    v_cvt_pk_bf16_f32 v72, v196, v197
    v_cvt_pk_bf16_f32 v73, v198, v199
    v_cvt_pk_bf16_f32 v74, v200, v201
    v_cvt_pk_bf16_f32 v75, v202, v203
    v_cvt_pk_bf16_f32 v76, v208, v209
    v_cvt_pk_bf16_f32 v77, v210, v211
    v_cvt_pk_bf16_f32 v78, v212, v213
    v_cvt_pk_bf16_f32 v79, v214, v215
    v_cvt_pk_bf16_f32 v80, v204, v205
    v_cvt_pk_bf16_f32 v81, v206, v207
    s_mul_i32 s36, s31, 2
    s_add_u32 s36, s36, s33
    s_mul_i32 s37, s32, 1
    s_add_u32 s36, s36, s37
    s_add_u32 s37, s36, s31
    buffer_store_dwordx4 v[72:75], v20, s[16:19], s36 offen sc0 sc1
    buffer_store_dwordx4 v[76:79], v20, s[16:19], s37 offen sc0 sc1
    buffer_store_dwordx2 v[80:81], v21, s[16:19], s36 offen sc0 sc1
    v_cvt_pk_bf16_f32 v48, v216, v217
    v_cvt_pk_bf16_f32 v49, v218, v219
    v_cvt_pk_bf16_f32 v50, v220, v221
    v_cvt_pk_bf16_f32 v51, v222, v223
    v_cvt_pk_bf16_f32 v52, v228, v229
    v_cvt_pk_bf16_f32 v53, v230, v231
    v_cvt_pk_bf16_f32 v54, v232, v233
    v_cvt_pk_bf16_f32 v55, v234, v235
    v_cvt_pk_bf16_f32 v56, v224, v225
    v_cvt_pk_bf16_f32 v57, v226, v227
    s_mul_i32 s36, s31, 4
    s_add_u32 s36, s36, s33
    s_mul_i32 s37, s32, 1
    s_add_u32 s36, s36, s37
    s_add_u32 s37, s36, s31
    buffer_store_dwordx4 v[48:51], v20, s[16:19], s36 offen sc0 sc1
    buffer_store_dwordx4 v[52:55], v20, s[16:19], s37 offen sc0 sc1
    buffer_store_dwordx2 v[56:57], v21, s[16:19], s36 offen sc0 sc1
    v_cvt_pk_bf16_f32 v60, v236, v237
    v_cvt_pk_bf16_f32 v61, v238, v239
    v_cvt_pk_bf16_f32 v62, v240, v241
    v_cvt_pk_bf16_f32 v63, v242, v243
    v_cvt_pk_bf16_f32 v64, v248, v249
    v_cvt_pk_bf16_f32 v65, v250, v251
    v_cvt_pk_bf16_f32 v66, v252, v253
    v_cvt_pk_bf16_f32 v67, v254, v255
    v_cvt_pk_bf16_f32 v68, v244, v245
    v_cvt_pk_bf16_f32 v69, v246, v247
    s_mul_i32 s36, s31, 6
    s_add_u32 s36, s36, s33
    s_mul_i32 s37, s32, 1
    s_add_u32 s36, s36, s37
    s_add_u32 s37, s36, s31
    buffer_store_dwordx4 v[60:63], v20, s[16:19], s36 offen sc0 sc1
    buffer_store_dwordx4 v[64:67], v20, s[16:19], s37 offen sc0 sc1
    buffer_store_dwordx2 v[68:69], v21, s[16:19], s36 offen sc0 sc1
    s_endpgm
L_parallel_sum__mha_block__glu_gated_bilinear__prompt_kernel_v:
    v_and_b32 v2, 31, v1
    v_lshrrev_b32 v3, 5, v1
    s_lshl_b32 s23, s22, 6
    v_add_u32 v21, s23, v2
    v_lshlrev_b32 v21, 7, v21
    v_bfe_u32 v22, v1, 1, 3
    v_xor_b32 v23, v3, v22
    v_lshlrev_b32 v23, 4, v23
    v_add_u32 v4, v21, v23
    v_add_u32 v4, 3072, v4
    v_xor_b32 v5, 32, v4
    v_xor_b32 v6, 64, v4
    v_xor_b32 v7, 96, v4
    v_bfe_u32 v21, v1, 2, 2
    v_lshlrev_b32 v22, 3, v3
    v_add_u32 v21, v21, v22
    v_mul_u32_u24 v21, 320, v21
    v_bfe_u32 v22, v1, 4, 1
    v_lshlrev_b32 v22, 5, v22
    v_and_b32 v23, 3, v1
    v_lshlrev_b32 v23, 3, v23
    v_add_u32 v21, v21, v22
    v_add_u32 v20, v21, v23
    v_add_u32 v20, 101376, v20
    v_mov_b32 v96, 0
    v_mov_b32 v97, 0
    v_mov_b32 v98, 0
    v_mov_b32 v99, 0
    v_mov_b32 v100, 0
    v_mov_b32 v101, 0
    v_mov_b32 v102, 0
    v_mov_b32 v103, 0
    v_mov_b32 v104, 0
    v_mov_b32 v105, 0
    v_mov_b32 v106, 0
    v_mov_b32 v107, 0
    v_mov_b32 v108, 0
    v_mov_b32 v109, 0
    v_mov_b32 v110, 0
    v_mov_b32 v111, 0
    v_mov_b32 v112, 0
    v_mov_b32 v113, 0
    v_mov_b32 v114, 0
    v_mov_b32 v115, 0
    v_mov_b32 v116, 0
    v_mov_b32 v117, 0
    v_mov_b32 v118, 0
    v_mov_b32 v119, 0
    v_mov_b32 v120, 0
    v_mov_b32 v121, 0
    v_mov_b32 v122, 0
    v_mov_b32 v123, 0
    v_mov_b32 v124, 0
    v_mov_b32 v125, 0
    v_mov_b32 v126, 0
    v_mov_b32 v127, 0
    v_mov_b32 v128, 0
    v_mov_b32 v129, 0
    v_mov_b32 v130, 0
    v_mov_b32 v131, 0
    v_mov_b32 v132, 0
    v_mov_b32 v133, 0
    v_mov_b32 v134, 0
    v_mov_b32 v135, 0
    v_mov_b32 v136, 0
    v_mov_b32 v137, 0
    v_mov_b32 v138, 0
    v_mov_b32 v139, 0
    v_mov_b32 v140, 0
    v_mov_b32 v141, 0
    v_mov_b32 v142, 0
    v_mov_b32 v143, 0
    v_mov_b32 v144, 0
    v_mov_b32 v145, 0
    v_mov_b32 v146, 0
    v_mov_b32 v147, 0
    v_mov_b32 v148, 0
    v_mov_b32 v149, 0
    v_mov_b32 v150, 0
    v_mov_b32 v151, 0
    v_mov_b32 v152, 0
    v_mov_b32 v153, 0
    v_mov_b32 v154, 0
    v_mov_b32 v155, 0
    v_mov_b32 v156, 0
    v_mov_b32 v157, 0
    v_mov_b32 v158, 0
    v_mov_b32 v159, 0
    v_mov_b32 v160, 0
    v_mov_b32 v161, 0
    v_mov_b32 v162, 0
    v_mov_b32 v163, 0
    v_mov_b32 v164, 0
    v_mov_b32 v165, 0
    v_mov_b32 v166, 0
    v_mov_b32 v167, 0
    v_mov_b32 v168, 0
    v_mov_b32 v169, 0
    v_mov_b32 v170, 0
    v_mov_b32 v171, 0
    v_mov_b32 v172, 0
    v_mov_b32 v173, 0
    v_mov_b32 v174, 0
    v_mov_b32 v175, 0
    v_mov_b32 v176, 0
    v_mov_b32 v177, 0
    v_mov_b32 v178, 0
    v_mov_b32 v179, 0
    v_mov_b32 v180, 0
    v_mov_b32 v181, 0
    v_mov_b32 v182, 0
    v_mov_b32 v183, 0
    v_mov_b32 v184, 0
    v_mov_b32 v185, 0
    v_mov_b32 v186, 0
    v_mov_b32 v187, 0
    v_mov_b32 v188, 0
    v_mov_b32 v189, 0
    v_mov_b32 v190, 0
    v_mov_b32 v191, 0
    v_mov_b32 v192, 0
    v_mov_b32 v193, 0
    v_mov_b32 v194, 0
    v_mov_b32 v195, 0
    v_mov_b32 v196, 0
    v_mov_b32 v197, 0
    v_mov_b32 v198, 0
    v_mov_b32 v199, 0
    v_mov_b32 v200, 0
    v_mov_b32 v201, 0
    v_mov_b32 v202, 0
    v_mov_b32 v203, 0
    v_mov_b32 v204, 0
    v_mov_b32 v205, 0
    v_mov_b32 v206, 0
    v_mov_b32 v207, 0
    v_mov_b32 v208, 0
    v_mov_b32 v209, 0
    v_mov_b32 v210, 0
    v_mov_b32 v211, 0
    v_mov_b32 v212, 0
    v_mov_b32 v213, 0
    v_mov_b32 v214, 0
    v_mov_b32 v215, 0
    v_mov_b32 v216, 0
    v_mov_b32 v217, 0
    v_mov_b32 v218, 0
    v_mov_b32 v219, 0
    v_mov_b32 v220, 0
    v_mov_b32 v221, 0
    v_mov_b32 v222, 0
    v_mov_b32 v223, 0
    v_mov_b32 v224, 0
    v_mov_b32 v225, 0
    v_mov_b32 v226, 0
    v_mov_b32 v227, 0
    v_mov_b32 v228, 0
    v_mov_b32 v229, 0
    v_mov_b32 v230, 0
    v_mov_b32 v231, 0
    v_mov_b32 v232, 0
    v_mov_b32 v233, 0
    v_mov_b32 v234, 0
    v_mov_b32 v235, 0
    v_mov_b32 v236, 0
    v_mov_b32 v237, 0
    v_mov_b32 v238, 0
    v_mov_b32 v239, 0
    v_mov_b32 v240, 0
    v_mov_b32 v241, 0
    v_mov_b32 v242, 0
    v_mov_b32 v243, 0
    v_mov_b32 v244, 0
    v_mov_b32 v245, 0
    v_mov_b32 v246, 0
    v_mov_b32 v247, 0
    v_mov_b32 v248, 0
    v_mov_b32 v249, 0
    v_mov_b32 v250, 0
    v_mov_b32 v251, 0
    v_mov_b32 v252, 0
    v_mov_b32 v253, 0
    v_mov_b32 v254, 0
    v_mov_b32 v255, 0
    v_cmp_gt_u32 vcc, 32, v1
    v_mov_b32 v10, 0x7ffffff0
    s_cmp_lg_u32 s22, 0
    s_cbranch_scc1 L_parallel_sum__mha_block__glu_gated_bilinear__prompt_kernel_v_pfw
    s_mul_i32 s56, s20, 327680
    s_add_u32 s52, s68, s56
    s_addc_u32 s53, s69, 0
    s_mov_b32 s54, 327680
    s_and_b32 s56, s21, 7
    s_lshl_b32 s56, s56, 5
    v_add_u32 v8, s56, v2
    v_mul_u32_u24 v8, 1280, v8
    s_mov_b32 s57, 128
    s_mov_b32 s58, 1280
    s_branch L_parallel_sum__mha_block__glu_gated_bilinear__prompt_kernel_v_pfd
L_parallel_sum__mha_block__glu_gated_bilinear__prompt_kernel_v_pfw:
    s_mov_b32 s52, s70
    s_mov_b32 s53, s71
    s_mul_i32 s56, s21, 320
    s_and_b32 s56, s56, 0xffffff80
    s_cmp_eq_u32 s22, 2
    s_cselect_b32 s57, 256, 0
    s_add_u32 s56, s56, s57
    s_mov_b32 s54, 2457600
    s_cmp_eq_u32 s22, 3
    s_cselect_b32 s54, 0, s54
    s_and_b32 s57, s20, 3
    s_mul_i32 s57, s57, 61440
    s_add_u32 s56, s56, s57
    v_lshrrev_b32 v8, 1, v1
    v_mul_u32_u24 v8, 3840, v8
    v_and_b32 v9, 1, v1
    v_lshlrev_b32 v9, 7, v9
    v_add3_u32 v8, v8, v9, s56
    s_mov_b32 s57, 245760
    s_mov_b32 s58, 0x7fffffff
L_parallel_sum__mha_block__glu_gated_bilinear__prompt_kernel_v_pfd:
    v_cndmask_b32 v8, v10, v8, vcc
    s_mov_b32 s55, 0x20000
    s_mul_i32 s56, s57, 2
    buffer_load_dword v9, v8, s[52:55], s56 offen
    s_add_u32 s56, s56, s57
    buffer_load_dword v9, v8, s[52:55], s56 offen
    s_add_u32 s56, s56, s57
    s_barrier
    ds_read_b128 v[32:35], v4 offset:0
    ds_read_b128 v[36:39], v4 offset:4096
    ds_read_b64_tr_b16 v[48:49], v20 offset:0
    ds_read_b64_tr_b16 v[50:51], v20 offset:1280
    ds_read_b64_tr_b16 v[52:53], v20 offset:64
    ds_read_b64_tr_b16 v[54:55], v20 offset:1344
    ds_read_b64_tr_b16 v[56:57], v20 offset:128
    ds_read_b64_tr_b16 v[58:59], v20 offset:1408
    ds_read_b64_tr_b16 v[60:61], v20 offset:192
    ds_read_b64_tr_b16 v[62:63], v20 offset:1472
    s_mov_b32 s24, 0
    s_mov_b32 s25, 0
    s_mov_b32 s27, 0
L_parallel_sum__mha_block__glu_gated_bilinear__prompt_kernel_v_loop:
    s_waitcnt lgkmcnt(6)
    v_mfma_f32_32x32x16_bf16 v[96:111], v[32:35], v[48:51], v[96:111]
    ds_read_b64_tr_b16 v[64:65], v20 offset:256
    ds_read_b64_tr_b16 v[66:67], v20 offset:1536
    s_add_u32 s25, s25, 1
    s_cmp_eq_u32 s25, 5
    s_cselect_b32 s25, 0, s25
    s_mov_b32 s26, 12288
    s_cselect_b32 s26, 4294918144, s26
    v_mfma_f32_32x32x16_bf16 v[176:191], v[36:39], v[48:51], v[176:191]
    s_add_u32 s27, s27, 1
    s_cmp_eq_u32 s27, 3
    s_cselect_b32 s27, 0, s27
    s_mov_b32 s28, 32768
    s_cselect_b32 s28, 4294901760, s28
    s_waitcnt lgkmcnt(6)
    v_mfma_f32_32x32x16_bf16 v[112:127], v[32:35], v[52:55], v[112:127]
    ds_read_b64_tr_b16 v[48:49], v20 offset:5120
    ds_read_b64_tr_b16 v[50:51], v20 offset:6400
    v_mfma_f32_32x32x16_bf16 v[192:207], v[36:39], v[52:55], v[192:207]
    ds_read_b128 v[40:43], v5 offset:0
    ds_read_b128 v[44:47], v5 offset:4096
    s_waitcnt lgkmcnt(8)
    v_mfma_f32_32x32x16_bf16 v[128:143], v[32:35], v[56:59], v[128:143]
    ds_read_b64_tr_b16 v[52:53], v20 offset:5184
    ds_read_b64_tr_b16 v[54:55], v20 offset:6464
    v_mfma_f32_32x32x16_bf16 v[208:223], v[36:39], v[56:59], v[208:223]
    v_add_u32 v4, s28, v4
    s_waitcnt lgkmcnt(8)
    v_mfma_f32_32x32x16_bf16 v[144:159], v[32:35], v[60:63], v[144:159]
    ds_read_b64_tr_b16 v[56:57], v20 offset:5248
    ds_read_b64_tr_b16 v[58:59], v20 offset:6528
    v_mfma_f32_32x32x16_bf16 v[224:239], v[36:39], v[60:63], v[224:239]
    v_add_u32 v5, s28, v5
    s_waitcnt lgkmcnt(8)
    v_mfma_f32_32x32x16_bf16 v[160:175], v[32:35], v[64:67], v[160:175]
    ds_read_b64_tr_b16 v[60:61], v20 offset:5312
    ds_read_b64_tr_b16 v[62:63], v20 offset:6592
    s_cmp_lt_u32 s56, s58
    s_cselect_b32 s59, s56, 0x0ffffff0
    v_mfma_f32_32x32x16_bf16 v[240:255], v[36:39], v[64:67], v[240:255]
    buffer_load_dword v9, v8, s[52:55], s59 offen
    s_add_u32 s56, s56, s57
    s_waitcnt lgkmcnt(6)
    v_mfma_f32_32x32x16_bf16 v[96:111], v[40:43], v[48:51], v[96:111]
    ds_read_b64_tr_b16 v[64:65], v20 offset:5376
    ds_read_b64_tr_b16 v[66:67], v20 offset:6656
    v_mfma_f32_32x32x16_bf16 v[176:191], v[44:47], v[48:51], v[176:191]
    s_waitcnt lgkmcnt(6)
    v_mfma_f32_32x32x16_bf16 v[112:127], v[40:43], v[52:55], v[112:127]
    s_barrier
    v_add_u32 v20, s26, v20
    ds_read_b64_tr_b16 v[48:49], v20 offset:0
    ds_read_b64_tr_b16 v[50:51], v20 offset:1280
    v_mfma_f32_32x32x16_bf16 v[192:207], v[44:47], v[52:55], v[192:207]
    ds_read_b128 v[32:35], v6 offset:0
    ds_read_b128 v[36:39], v6 offset:4096
    s_waitcnt lgkmcnt(8)
    v_mfma_f32_32x32x16_bf16 v[128:143], v[40:43], v[56:59], v[128:143]
    ds_read_b64_tr_b16 v[52:53], v20 offset:64
    ds_read_b64_tr_b16 v[54:55], v20 offset:1344
    v_mfma_f32_32x32x16_bf16 v[208:223], v[44:47], v[56:59], v[208:223]
    s_waitcnt lgkmcnt(8)
    v_mfma_f32_32x32x16_bf16 v[144:159], v[40:43], v[60:63], v[144:159]
    ds_read_b64_tr_b16 v[56:57], v20 offset:128
    ds_read_b64_tr_b16 v[58:59], v20 offset:1408
    v_mfma_f32_32x32x16_bf16 v[224:239], v[44:47], v[60:63], v[224:239]
    s_waitcnt lgkmcnt(8)
    v_mfma_f32_32x32x16_bf16 v[160:175], v[40:43], v[64:67], v[160:175]
    ds_read_b64_tr_b16 v[60:61], v20 offset:192
    ds_read_b64_tr_b16 v[62:63], v20 offset:1472
    v_mfma_f32_32x32x16_bf16 v[240:255], v[44:47], v[64:67], v[240:255]
    s_waitcnt lgkmcnt(6)
    v_mfma_f32_32x32x16_bf16 v[96:111], v[32:35], v[48:51], v[96:111]
    ds_read_b64_tr_b16 v[64:65], v20 offset:256
    ds_read_b64_tr_b16 v[66:67], v20 offset:1536
    s_add_u32 s25, s25, 1
    s_cmp_eq_u32 s25, 5
    v_mfma_f32_32x32x16_bf16 v[176:191], v[36:39], v[48:51], v[176:191]
    s_cselect_b32 s25, 0, s25
    s_mov_b32 s26, 12288
    s_cselect_b32 s26, 4294918144, s26
    s_waitcnt lgkmcnt(6)
    v_mfma_f32_32x32x16_bf16 v[112:127], v[32:35], v[52:55], v[112:127]
    ds_read_b64_tr_b16 v[48:49], v20 offset:5120
    ds_read_b64_tr_b16 v[50:51], v20 offset:6400
    v_mfma_f32_32x32x16_bf16 v[192:207], v[36:39], v[52:55], v[192:207]
    ds_read_b128 v[40:43], v7 offset:0
    ds_read_b128 v[44:47], v7 offset:4096
    s_waitcnt lgkmcnt(8)
    v_mfma_f32_32x32x16_bf16 v[128:143], v[32:35], v[56:59], v[128:143]
    ds_read_b64_tr_b16 v[52:53], v20 offset:5184
    ds_read_b64_tr_b16 v[54:55], v20 offset:6464
    v_mfma_f32_32x32x16_bf16 v[208:223], v[36:39], v[56:59], v[208:223]
    v_add_u32 v6, s28, v6
    s_waitcnt lgkmcnt(8)
    v_mfma_f32_32x32x16_bf16 v[144:159], v[32:35], v[60:63], v[144:159]
    ds_read_b64_tr_b16 v[56:57], v20 offset:5248
    ds_read_b64_tr_b16 v[58:59], v20 offset:6528
    v_mfma_f32_32x32x16_bf16 v[224:239], v[36:39], v[60:63], v[224:239]
    v_add_u32 v7, s28, v7
    s_waitcnt lgkmcnt(8)
    v_mfma_f32_32x32x16_bf16 v[160:175], v[32:35], v[64:67], v[160:175]
    ds_read_b64_tr_b16 v[60:61], v20 offset:5312
    ds_read_b64_tr_b16 v[62:63], v20 offset:6592
    v_mfma_f32_32x32x16_bf16 v[240:255], v[36:39], v[64:67], v[240:255]
    s_waitcnt lgkmcnt(6)
    v_mfma_f32_32x32x16_bf16 v[96:111], v[40:43], v[48:51], v[96:111]
    ds_read_b64_tr_b16 v[64:65], v20 offset:5376
    ds_read_b64_tr_b16 v[66:67], v20 offset:6656
    v_mfma_f32_32x32x16_bf16 v[176:191], v[44:47], v[48:51], v[176:191]
    s_waitcnt lgkmcnt(6)
    v_mfma_f32_32x32x16_bf16 v[112:127], v[40:43], v[52:55], v[112:127]
    s_barrier
    v_add_u32 v20, s26, v20
    ds_read_b64_tr_b16 v[48:49], v20 offset:0
    ds_read_b64_tr_b16 v[50:51], v20 offset:1280
    v_mfma_f32_32x32x16_bf16 v[192:207], v[44:47], v[52:55], v[192:207]
    ds_read_b128 v[32:35], v4 offset:0
    ds_read_b128 v[36:39], v4 offset:4096
    s_waitcnt lgkmcnt(8)
    v_mfma_f32_32x32x16_bf16 v[128:143], v[40:43], v[56:59], v[128:143]
    ds_read_b64_tr_b16 v[52:53], v20 offset:64
    ds_read_b64_tr_b16 v[54:55], v20 offset:1344
    v_mfma_f32_32x32x16_bf16 v[208:223], v[44:47], v[56:59], v[208:223]
    s_waitcnt lgkmcnt(8)
    v_mfma_f32_32x32x16_bf16 v[144:159], v[40:43], v[60:63], v[144:159]
    ds_read_b64_tr_b16 v[56:57], v20 offset:128
    ds_read_b64_tr_b16 v[58:59], v20 offset:1408
    v_mfma_f32_32x32x16_bf16 v[224:239], v[44:47], v[60:63], v[224:239]
    s_waitcnt lgkmcnt(8)
    v_mfma_f32_32x32x16_bf16 v[160:175], v[40:43], v[64:67], v[160:175]
    ds_read_b64_tr_b16 v[60:61], v20 offset:192
    ds_read_b64_tr_b16 v[62:63], v20 offset:1472
    v_mfma_f32_32x32x16_bf16 v[240:255], v[44:47], v[64:67], v[240:255]
    s_add_u32 s24, s24, 1
    s_cmp_lt_u32 s24, 10
    s_cbranch_scc1 L_parallel_sum__mha_block__glu_gated_bilinear__prompt_kernel_v_loop
    s_waitcnt vmcnt(0) lgkmcnt(0)
    s_nop 15
    v_lshlrev_b32 v11, 4, v3
    s_lshl_b32 s24, s23, 2
    v_add_u32 v11, s24, v11
    v_lshlrev_b32 v12, 2, v2
    ds_read_b128 v[32:35], v11 offset:0
    ds_read_b128 v[64:67], v11 offset:1024
    ds_read_b128 v[36:39], v11 offset:32
    ds_read_b128 v[68:71], v11 offset:1056
    ds_read_b128 v[40:43], v11 offset:64
    ds_read_b128 v[72:75], v11 offset:1088
    ds_read_b128 v[44:47], v11 offset:96
    ds_read_b128 v[76:79], v11 offset:1120
    ds_read_b128 v[48:51], v11 offset:128
    ds_read_b128 v[80:83], v11 offset:1152
    ds_read_b128 v[52:55], v11 offset:160
    ds_read_b128 v[84:87], v11 offset:1184
    ds_read_b128 v[56:59], v11 offset:192
    ds_read_b128 v[88:91], v11 offset:1216
    ds_read_b128 v[60:63], v11 offset:224
    ds_read_b128 v[92:95], v11 offset:1248
    ds_read_b32 v14, v12 offset:2048
    ds_read_b32 v16, v12 offset:2176
    ds_read_b32 v18, v12 offset:2304
    ds_read_b32 v20, v12 offset:2432
    ds_read_b32 v22, v12 offset:2560
    s_sub_u32 s34, s21, 8
    s_lshl_b32 s34, s34, 3
    s_mul_i32 s34, s34, 163840
    s_add_u32 s33, s34, 2622720
    s_lshl_b32 s35, s20, 3
    s_lshl_b32 s36, s22, 1
    s_add_u32 s35, s35, s36
    s_mul_i32 s35, s35, 2560
    s_add_u32 s33, s33, s35
    s_mov_b32 s37, 163840
    v_mul_u32_u24 v24, 320, v3
    v_add_u32 v13, 0, v2
    v_mul_u32_u24 v30, 205, v13
    v_lshrrev_b32 v30, 12, v30
    v_mul_u32_u24 v31, 20, v30
    v_sub_u32 v13, v13, v31
    v_lshlrev_b32 v13, 4, v13
    v_mul_lo_u32 v30, v30, s37
    v_add_u32 v13, v13, v30
    v_add_u32 v25, v13, v24
    v_add_u32 v13, 32, v2
    v_mul_u32_u24 v30, 205, v13
    v_lshrrev_b32 v30, 12, v30
    v_mul_u32_u24 v31, 20, v30
    v_sub_u32 v13, v13, v31
    v_lshlrev_b32 v13, 4, v13
    v_mul_lo_u32 v30, v30, s37
    v_add_u32 v13, v13, v30
    v_add_u32 v26, v13, v24
    v_add_u32 v13, 64, v2
    v_mul_u32_u24 v30, 205, v13
    v_lshrrev_b32 v30, 12, v30
    v_mul_u32_u24 v31, 20, v30
    v_sub_u32 v13, v13, v31
    v_lshlrev_b32 v13, 4, v13
    v_mul_lo_u32 v30, v30, s37
    v_add_u32 v13, v13, v30
    v_add_u32 v27, v13, v24
    v_add_u32 v13, 96, v2
    v_mul_u32_u24 v30, 205, v13
    v_lshrrev_b32 v30, 12, v30
    v_mul_u32_u24 v31, 20, v30
    v_sub_u32 v13, v13, v31
    v_lshlrev_b32 v13, 4, v13
    v_mul_lo_u32 v30, v30, s37
    v_add_u32 v13, v13, v30
    v_add_u32 v28, v13, v24
    v_add_u32 v13, 128, v2
    v_mul_u32_u24 v30, 205, v13
    v_lshrrev_b32 v30, 12, v30
    v_mul_u32_u24 v31, 20, v30
    v_sub_u32 v13, v13, v31
    v_lshlrev_b32 v13, 4, v13
    v_mul_lo_u32 v30, v30, s37
    v_add_u32 v13, v13, v30
    v_add_u32 v29, v13, v24
    s_waitcnt lgkmcnt(0)
    v_sub_f32 v14, 0, v14
    v_sub_f32 v16, 0, v16
    v_sub_f32 v18, 0, v18
    v_sub_f32 v20, 0, v20
    v_sub_f32 v22, 0, v22
    v_pk_fma_f32 v[96:97], v[32:33], v[14:15], v[96:97] op_sel_hi:[1,0,1]
    v_pk_fma_f32 v[98:99], v[34:35], v[14:15], v[98:99] op_sel_hi:[1,0,1]
    v_pk_fma_f32 v[100:101], v[36:37], v[14:15], v[100:101] op_sel_hi:[1,0,1]
    v_pk_fma_f32 v[102:103], v[38:39], v[14:15], v[102:103] op_sel_hi:[1,0,1]
    v_pk_fma_f32 v[104:105], v[40:41], v[14:15], v[104:105] op_sel_hi:[1,0,1]
    v_pk_fma_f32 v[106:107], v[42:43], v[14:15], v[106:107] op_sel_hi:[1,0,1]
    v_pk_fma_f32 v[108:109], v[44:45], v[14:15], v[108:109] op_sel_hi:[1,0,1]
    v_pk_fma_f32 v[110:111], v[46:47], v[14:15], v[110:111] op_sel_hi:[1,0,1]
    v_pk_mul_f32 v[96:97], v[96:97], v[64:65]
    v_pk_mul_f32 v[98:99], v[98:99], v[66:67]
    v_pk_mul_f32 v[100:101], v[100:101], v[68:69]
    v_pk_mul_f32 v[102:103], v[102:103], v[70:71]
    v_pk_mul_f32 v[104:105], v[104:105], v[72:73]
    v_pk_mul_f32 v[106:107], v[106:107], v[74:75]
    v_pk_mul_f32 v[108:109], v[108:109], v[76:77]
    v_pk_mul_f32 v[110:111], v[110:111], v[78:79]
    v_cvt_pk_bf16_f32 v96, v96, v97
    v_cvt_pk_bf16_f32 v97, v98, v99
    v_cvt_pk_bf16_f32 v98, v100, v101
    v_cvt_pk_bf16_f32 v99, v102, v103
    s_add_u32 s36, s33, 0
    buffer_store_dwordx4 v[96:99], v25, s[16:19], s36 offen sc0 sc1
    v_cvt_pk_bf16_f32 v104, v104, v105
    v_cvt_pk_bf16_f32 v105, v106, v107
    v_cvt_pk_bf16_f32 v106, v108, v109
    v_cvt_pk_bf16_f32 v107, v110, v111
    s_add_u32 s36, s33, 640
    buffer_store_dwordx4 v[104:107], v25, s[16:19], s36 offen sc0 sc1
    v_pk_fma_f32 v[176:177], v[48:49], v[14:15], v[176:177] op_sel_hi:[1,0,1]
    v_pk_fma_f32 v[178:179], v[50:51], v[14:15], v[178:179] op_sel_hi:[1,0,1]
    v_pk_fma_f32 v[180:181], v[52:53], v[14:15], v[180:181] op_sel_hi:[1,0,1]
    v_pk_fma_f32 v[182:183], v[54:55], v[14:15], v[182:183] op_sel_hi:[1,0,1]
    v_pk_fma_f32 v[184:185], v[56:57], v[14:15], v[184:185] op_sel_hi:[1,0,1]
    v_pk_fma_f32 v[186:187], v[58:59], v[14:15], v[186:187] op_sel_hi:[1,0,1]
    v_pk_fma_f32 v[188:189], v[60:61], v[14:15], v[188:189] op_sel_hi:[1,0,1]
    v_pk_fma_f32 v[190:191], v[62:63], v[14:15], v[190:191] op_sel_hi:[1,0,1]
    v_pk_mul_f32 v[176:177], v[176:177], v[80:81]
    v_pk_mul_f32 v[178:179], v[178:179], v[82:83]
    v_pk_mul_f32 v[180:181], v[180:181], v[84:85]
    v_pk_mul_f32 v[182:183], v[182:183], v[86:87]
    v_pk_mul_f32 v[184:185], v[184:185], v[88:89]
    v_pk_mul_f32 v[186:187], v[186:187], v[90:91]
    v_pk_mul_f32 v[188:189], v[188:189], v[92:93]
    v_pk_mul_f32 v[190:191], v[190:191], v[94:95]
    v_cvt_pk_bf16_f32 v176, v176, v177
    v_cvt_pk_bf16_f32 v177, v178, v179
    v_cvt_pk_bf16_f32 v178, v180, v181
    v_cvt_pk_bf16_f32 v179, v182, v183
    s_add_u32 s36, s33, 2560
    buffer_store_dwordx4 v[176:179], v25, s[16:19], s36 offen sc0 sc1
    v_cvt_pk_bf16_f32 v184, v184, v185
    v_cvt_pk_bf16_f32 v185, v186, v187
    v_cvt_pk_bf16_f32 v186, v188, v189
    v_cvt_pk_bf16_f32 v187, v190, v191
    s_add_u32 s36, s33, 3200
    buffer_store_dwordx4 v[184:187], v25, s[16:19], s36 offen sc0 sc1
    v_pk_fma_f32 v[112:113], v[32:33], v[16:17], v[112:113] op_sel_hi:[1,0,1]
    v_pk_fma_f32 v[114:115], v[34:35], v[16:17], v[114:115] op_sel_hi:[1,0,1]
    v_pk_fma_f32 v[116:117], v[36:37], v[16:17], v[116:117] op_sel_hi:[1,0,1]
    v_pk_fma_f32 v[118:119], v[38:39], v[16:17], v[118:119] op_sel_hi:[1,0,1]
    v_pk_fma_f32 v[120:121], v[40:41], v[16:17], v[120:121] op_sel_hi:[1,0,1]
    v_pk_fma_f32 v[122:123], v[42:43], v[16:17], v[122:123] op_sel_hi:[1,0,1]
    v_pk_fma_f32 v[124:125], v[44:45], v[16:17], v[124:125] op_sel_hi:[1,0,1]
    v_pk_fma_f32 v[126:127], v[46:47], v[16:17], v[126:127] op_sel_hi:[1,0,1]
    v_pk_mul_f32 v[112:113], v[112:113], v[64:65]
    v_pk_mul_f32 v[114:115], v[114:115], v[66:67]
    v_pk_mul_f32 v[116:117], v[116:117], v[68:69]
    v_pk_mul_f32 v[118:119], v[118:119], v[70:71]
    v_pk_mul_f32 v[120:121], v[120:121], v[72:73]
    v_pk_mul_f32 v[122:123], v[122:123], v[74:75]
    v_pk_mul_f32 v[124:125], v[124:125], v[76:77]
    v_pk_mul_f32 v[126:127], v[126:127], v[78:79]
    v_cvt_pk_bf16_f32 v112, v112, v113
    v_cvt_pk_bf16_f32 v113, v114, v115
    v_cvt_pk_bf16_f32 v114, v116, v117
    v_cvt_pk_bf16_f32 v115, v118, v119
    s_add_u32 s36, s33, 0
    buffer_store_dwordx4 v[112:115], v26, s[16:19], s36 offen sc0 sc1
    v_cvt_pk_bf16_f32 v120, v120, v121
    v_cvt_pk_bf16_f32 v121, v122, v123
    v_cvt_pk_bf16_f32 v122, v124, v125
    v_cvt_pk_bf16_f32 v123, v126, v127
    s_add_u32 s36, s33, 640
    buffer_store_dwordx4 v[120:123], v26, s[16:19], s36 offen sc0 sc1
    v_pk_fma_f32 v[192:193], v[48:49], v[16:17], v[192:193] op_sel_hi:[1,0,1]
    v_pk_fma_f32 v[194:195], v[50:51], v[16:17], v[194:195] op_sel_hi:[1,0,1]
    v_pk_fma_f32 v[196:197], v[52:53], v[16:17], v[196:197] op_sel_hi:[1,0,1]
    v_pk_fma_f32 v[198:199], v[54:55], v[16:17], v[198:199] op_sel_hi:[1,0,1]
    v_pk_fma_f32 v[200:201], v[56:57], v[16:17], v[200:201] op_sel_hi:[1,0,1]
    v_pk_fma_f32 v[202:203], v[58:59], v[16:17], v[202:203] op_sel_hi:[1,0,1]
    v_pk_fma_f32 v[204:205], v[60:61], v[16:17], v[204:205] op_sel_hi:[1,0,1]
    v_pk_fma_f32 v[206:207], v[62:63], v[16:17], v[206:207] op_sel_hi:[1,0,1]
    v_pk_mul_f32 v[192:193], v[192:193], v[80:81]
    v_pk_mul_f32 v[194:195], v[194:195], v[82:83]
    v_pk_mul_f32 v[196:197], v[196:197], v[84:85]
    v_pk_mul_f32 v[198:199], v[198:199], v[86:87]
    v_pk_mul_f32 v[200:201], v[200:201], v[88:89]
    v_pk_mul_f32 v[202:203], v[202:203], v[90:91]
    v_pk_mul_f32 v[204:205], v[204:205], v[92:93]
    v_pk_mul_f32 v[206:207], v[206:207], v[94:95]
    v_cvt_pk_bf16_f32 v192, v192, v193
    v_cvt_pk_bf16_f32 v193, v194, v195
    v_cvt_pk_bf16_f32 v194, v196, v197
    v_cvt_pk_bf16_f32 v195, v198, v199
    s_add_u32 s36, s33, 2560
    buffer_store_dwordx4 v[192:195], v26, s[16:19], s36 offen sc0 sc1
    v_cvt_pk_bf16_f32 v200, v200, v201
    v_cvt_pk_bf16_f32 v201, v202, v203
    v_cvt_pk_bf16_f32 v202, v204, v205
    v_cvt_pk_bf16_f32 v203, v206, v207
    s_add_u32 s36, s33, 3200
    buffer_store_dwordx4 v[200:203], v26, s[16:19], s36 offen sc0 sc1
    v_pk_fma_f32 v[128:129], v[32:33], v[18:19], v[128:129] op_sel_hi:[1,0,1]
    v_pk_fma_f32 v[130:131], v[34:35], v[18:19], v[130:131] op_sel_hi:[1,0,1]
    v_pk_fma_f32 v[132:133], v[36:37], v[18:19], v[132:133] op_sel_hi:[1,0,1]
    v_pk_fma_f32 v[134:135], v[38:39], v[18:19], v[134:135] op_sel_hi:[1,0,1]
    v_pk_fma_f32 v[136:137], v[40:41], v[18:19], v[136:137] op_sel_hi:[1,0,1]
    v_pk_fma_f32 v[138:139], v[42:43], v[18:19], v[138:139] op_sel_hi:[1,0,1]
    v_pk_fma_f32 v[140:141], v[44:45], v[18:19], v[140:141] op_sel_hi:[1,0,1]
    v_pk_fma_f32 v[142:143], v[46:47], v[18:19], v[142:143] op_sel_hi:[1,0,1]
    v_pk_mul_f32 v[128:129], v[128:129], v[64:65]
    v_pk_mul_f32 v[130:131], v[130:131], v[66:67]
    v_pk_mul_f32 v[132:133], v[132:133], v[68:69]
    v_pk_mul_f32 v[134:135], v[134:135], v[70:71]
    v_pk_mul_f32 v[136:137], v[136:137], v[72:73]
    v_pk_mul_f32 v[138:139], v[138:139], v[74:75]
    v_pk_mul_f32 v[140:141], v[140:141], v[76:77]
    v_pk_mul_f32 v[142:143], v[142:143], v[78:79]
    v_cvt_pk_bf16_f32 v128, v128, v129
    v_cvt_pk_bf16_f32 v129, v130, v131
    v_cvt_pk_bf16_f32 v130, v132, v133
    v_cvt_pk_bf16_f32 v131, v134, v135
    s_add_u32 s36, s33, 0
    buffer_store_dwordx4 v[128:131], v27, s[16:19], s36 offen sc0 sc1
    v_cvt_pk_bf16_f32 v136, v136, v137
    v_cvt_pk_bf16_f32 v137, v138, v139
    v_cvt_pk_bf16_f32 v138, v140, v141
    v_cvt_pk_bf16_f32 v139, v142, v143
    s_add_u32 s36, s33, 640
    buffer_store_dwordx4 v[136:139], v27, s[16:19], s36 offen sc0 sc1
    v_pk_fma_f32 v[208:209], v[48:49], v[18:19], v[208:209] op_sel_hi:[1,0,1]
    v_pk_fma_f32 v[210:211], v[50:51], v[18:19], v[210:211] op_sel_hi:[1,0,1]
    v_pk_fma_f32 v[212:213], v[52:53], v[18:19], v[212:213] op_sel_hi:[1,0,1]
    v_pk_fma_f32 v[214:215], v[54:55], v[18:19], v[214:215] op_sel_hi:[1,0,1]
    v_pk_fma_f32 v[216:217], v[56:57], v[18:19], v[216:217] op_sel_hi:[1,0,1]
    v_pk_fma_f32 v[218:219], v[58:59], v[18:19], v[218:219] op_sel_hi:[1,0,1]
    v_pk_fma_f32 v[220:221], v[60:61], v[18:19], v[220:221] op_sel_hi:[1,0,1]
    v_pk_fma_f32 v[222:223], v[62:63], v[18:19], v[222:223] op_sel_hi:[1,0,1]
    v_pk_mul_f32 v[208:209], v[208:209], v[80:81]
    v_pk_mul_f32 v[210:211], v[210:211], v[82:83]
    v_pk_mul_f32 v[212:213], v[212:213], v[84:85]
    v_pk_mul_f32 v[214:215], v[214:215], v[86:87]
    v_pk_mul_f32 v[216:217], v[216:217], v[88:89]
    v_pk_mul_f32 v[218:219], v[218:219], v[90:91]
    v_pk_mul_f32 v[220:221], v[220:221], v[92:93]
    v_pk_mul_f32 v[222:223], v[222:223], v[94:95]
    v_cvt_pk_bf16_f32 v208, v208, v209
    v_cvt_pk_bf16_f32 v209, v210, v211
    v_cvt_pk_bf16_f32 v210, v212, v213
    v_cvt_pk_bf16_f32 v211, v214, v215
    s_add_u32 s36, s33, 2560
    buffer_store_dwordx4 v[208:211], v27, s[16:19], s36 offen sc0 sc1
    v_cvt_pk_bf16_f32 v216, v216, v217
    v_cvt_pk_bf16_f32 v217, v218, v219
    v_cvt_pk_bf16_f32 v218, v220, v221
    v_cvt_pk_bf16_f32 v219, v222, v223
    s_add_u32 s36, s33, 3200
    buffer_store_dwordx4 v[216:219], v27, s[16:19], s36 offen sc0 sc1
    v_pk_fma_f32 v[144:145], v[32:33], v[20:21], v[144:145] op_sel_hi:[1,0,1]
    v_pk_fma_f32 v[146:147], v[34:35], v[20:21], v[146:147] op_sel_hi:[1,0,1]
    v_pk_fma_f32 v[148:149], v[36:37], v[20:21], v[148:149] op_sel_hi:[1,0,1]
    v_pk_fma_f32 v[150:151], v[38:39], v[20:21], v[150:151] op_sel_hi:[1,0,1]
    v_pk_fma_f32 v[152:153], v[40:41], v[20:21], v[152:153] op_sel_hi:[1,0,1]
    v_pk_fma_f32 v[154:155], v[42:43], v[20:21], v[154:155] op_sel_hi:[1,0,1]
    v_pk_fma_f32 v[156:157], v[44:45], v[20:21], v[156:157] op_sel_hi:[1,0,1]
    v_pk_fma_f32 v[158:159], v[46:47], v[20:21], v[158:159] op_sel_hi:[1,0,1]
    v_pk_mul_f32 v[144:145], v[144:145], v[64:65]
    v_pk_mul_f32 v[146:147], v[146:147], v[66:67]
    v_pk_mul_f32 v[148:149], v[148:149], v[68:69]
    v_pk_mul_f32 v[150:151], v[150:151], v[70:71]
    v_pk_mul_f32 v[152:153], v[152:153], v[72:73]
    v_pk_mul_f32 v[154:155], v[154:155], v[74:75]
    v_pk_mul_f32 v[156:157], v[156:157], v[76:77]
    v_pk_mul_f32 v[158:159], v[158:159], v[78:79]
    v_cvt_pk_bf16_f32 v144, v144, v145
    v_cvt_pk_bf16_f32 v145, v146, v147
    v_cvt_pk_bf16_f32 v146, v148, v149
    v_cvt_pk_bf16_f32 v147, v150, v151
    s_add_u32 s36, s33, 0
    buffer_store_dwordx4 v[144:147], v28, s[16:19], s36 offen sc0 sc1
    v_cvt_pk_bf16_f32 v152, v152, v153
    v_cvt_pk_bf16_f32 v153, v154, v155
    v_cvt_pk_bf16_f32 v154, v156, v157
    v_cvt_pk_bf16_f32 v155, v158, v159
    s_add_u32 s36, s33, 640
    buffer_store_dwordx4 v[152:155], v28, s[16:19], s36 offen sc0 sc1
    v_pk_fma_f32 v[224:225], v[48:49], v[20:21], v[224:225] op_sel_hi:[1,0,1]
    v_pk_fma_f32 v[226:227], v[50:51], v[20:21], v[226:227] op_sel_hi:[1,0,1]
    v_pk_fma_f32 v[228:229], v[52:53], v[20:21], v[228:229] op_sel_hi:[1,0,1]
    v_pk_fma_f32 v[230:231], v[54:55], v[20:21], v[230:231] op_sel_hi:[1,0,1]
    v_pk_fma_f32 v[232:233], v[56:57], v[20:21], v[232:233] op_sel_hi:[1,0,1]
    v_pk_fma_f32 v[234:235], v[58:59], v[20:21], v[234:235] op_sel_hi:[1,0,1]
    v_pk_fma_f32 v[236:237], v[60:61], v[20:21], v[236:237] op_sel_hi:[1,0,1]
    v_pk_fma_f32 v[238:239], v[62:63], v[20:21], v[238:239] op_sel_hi:[1,0,1]
    v_pk_mul_f32 v[224:225], v[224:225], v[80:81]
    v_pk_mul_f32 v[226:227], v[226:227], v[82:83]
    v_pk_mul_f32 v[228:229], v[228:229], v[84:85]
    v_pk_mul_f32 v[230:231], v[230:231], v[86:87]
    v_pk_mul_f32 v[232:233], v[232:233], v[88:89]
    v_pk_mul_f32 v[234:235], v[234:235], v[90:91]
    v_pk_mul_f32 v[236:237], v[236:237], v[92:93]
    v_pk_mul_f32 v[238:239], v[238:239], v[94:95]
    v_cvt_pk_bf16_f32 v224, v224, v225
    v_cvt_pk_bf16_f32 v225, v226, v227
    v_cvt_pk_bf16_f32 v226, v228, v229
    v_cvt_pk_bf16_f32 v227, v230, v231
    s_add_u32 s36, s33, 2560
    buffer_store_dwordx4 v[224:227], v28, s[16:19], s36 offen sc0 sc1
    v_cvt_pk_bf16_f32 v232, v232, v233
    v_cvt_pk_bf16_f32 v233, v234, v235
    v_cvt_pk_bf16_f32 v234, v236, v237
    v_cvt_pk_bf16_f32 v235, v238, v239
    s_add_u32 s36, s33, 3200
    buffer_store_dwordx4 v[232:235], v28, s[16:19], s36 offen sc0 sc1
    v_pk_fma_f32 v[160:161], v[32:33], v[22:23], v[160:161] op_sel_hi:[1,0,1]
    v_pk_fma_f32 v[162:163], v[34:35], v[22:23], v[162:163] op_sel_hi:[1,0,1]
    v_pk_fma_f32 v[164:165], v[36:37], v[22:23], v[164:165] op_sel_hi:[1,0,1]
    v_pk_fma_f32 v[166:167], v[38:39], v[22:23], v[166:167] op_sel_hi:[1,0,1]
    v_pk_fma_f32 v[168:169], v[40:41], v[22:23], v[168:169] op_sel_hi:[1,0,1]
    v_pk_fma_f32 v[170:171], v[42:43], v[22:23], v[170:171] op_sel_hi:[1,0,1]
    v_pk_fma_f32 v[172:173], v[44:45], v[22:23], v[172:173] op_sel_hi:[1,0,1]
    v_pk_fma_f32 v[174:175], v[46:47], v[22:23], v[174:175] op_sel_hi:[1,0,1]
    v_pk_mul_f32 v[160:161], v[160:161], v[64:65]
    v_pk_mul_f32 v[162:163], v[162:163], v[66:67]
    v_pk_mul_f32 v[164:165], v[164:165], v[68:69]
    v_pk_mul_f32 v[166:167], v[166:167], v[70:71]
    v_pk_mul_f32 v[168:169], v[168:169], v[72:73]
    v_pk_mul_f32 v[170:171], v[170:171], v[74:75]
    v_pk_mul_f32 v[172:173], v[172:173], v[76:77]
    v_pk_mul_f32 v[174:175], v[174:175], v[78:79]
    v_cvt_pk_bf16_f32 v160, v160, v161
    v_cvt_pk_bf16_f32 v161, v162, v163
    v_cvt_pk_bf16_f32 v162, v164, v165
    v_cvt_pk_bf16_f32 v163, v166, v167
    s_add_u32 s36, s33, 0
    buffer_store_dwordx4 v[160:163], v29, s[16:19], s36 offen sc0 sc1
    v_cvt_pk_bf16_f32 v168, v168, v169
    v_cvt_pk_bf16_f32 v169, v170, v171
    v_cvt_pk_bf16_f32 v170, v172, v173
    v_cvt_pk_bf16_f32 v171, v174, v175
    s_add_u32 s36, s33, 640
    buffer_store_dwordx4 v[168:171], v29, s[16:19], s36 offen sc0 sc1
    v_pk_fma_f32 v[240:241], v[48:49], v[22:23], v[240:241] op_sel_hi:[1,0,1]
    v_pk_fma_f32 v[242:243], v[50:51], v[22:23], v[242:243] op_sel_hi:[1,0,1]
    v_pk_fma_f32 v[244:245], v[52:53], v[22:23], v[244:245] op_sel_hi:[1,0,1]
    v_pk_fma_f32 v[246:247], v[54:55], v[22:23], v[246:247] op_sel_hi:[1,0,1]
    v_pk_fma_f32 v[248:249], v[56:57], v[22:23], v[248:249] op_sel_hi:[1,0,1]
    v_pk_fma_f32 v[250:251], v[58:59], v[22:23], v[250:251] op_sel_hi:[1,0,1]
    v_pk_fma_f32 v[252:253], v[60:61], v[22:23], v[252:253] op_sel_hi:[1,0,1]
    v_pk_fma_f32 v[254:255], v[62:63], v[22:23], v[254:255] op_sel_hi:[1,0,1]
    v_pk_mul_f32 v[240:241], v[240:241], v[80:81]
    v_pk_mul_f32 v[242:243], v[242:243], v[82:83]
    v_pk_mul_f32 v[244:245], v[244:245], v[84:85]
    v_pk_mul_f32 v[246:247], v[246:247], v[86:87]
    v_pk_mul_f32 v[248:249], v[248:249], v[88:89]
    v_pk_mul_f32 v[250:251], v[250:251], v[90:91]
    v_pk_mul_f32 v[252:253], v[252:253], v[92:93]
    v_pk_mul_f32 v[254:255], v[254:255], v[94:95]
    v_cvt_pk_bf16_f32 v240, v240, v241
    v_cvt_pk_bf16_f32 v241, v242, v243
    v_cvt_pk_bf16_f32 v242, v244, v245
    v_cvt_pk_bf16_f32 v243, v246, v247
    s_add_u32 s36, s33, 2560
    buffer_store_dwordx4 v[240:243], v29, s[16:19], s36 offen sc0 sc1
    v_cvt_pk_bf16_f32 v248, v248, v249
    v_cvt_pk_bf16_f32 v249, v250, v251
    v_cvt_pk_bf16_f32 v250, v252, v253
    v_cvt_pk_bf16_f32 v251, v254, v255
    s_add_u32 s36, s33, 3200
    buffer_store_dwordx4 v[248:251], v29, s[16:19], s36 offen sc0 sc1
    s_endpgm
L_parallel_sum__mha_block__glu_gated_bilinear__prompt_kernel_glu:
    v_and_b32 v2, 31, v1
    v_lshrrev_b32 v3, 5, v1
    s_lshl_b32 s23, s22, 6
    v_add_u32 v21, s23, v2
    v_lshlrev_b32 v21, 7, v21
    v_bfe_u32 v22, v1, 1, 3
    v_xor_b32 v23, v3, v22
    v_lshlrev_b32 v23, 4, v23
    v_add_u32 v4, v21, v23
    v_add_u32 v4, 3072, v4
    v_xor_b32 v5, 32, v4
    v_xor_b32 v6, 64, v4
    v_xor_b32 v7, 96, v4
    v_bfe_u32 v21, v1, 2, 2
    v_lshlrev_b32 v22, 3, v3
    v_add_u32 v21, v21, v22
    v_mul_u32_u24 v21, 192, v21
    v_bfe_u32 v22, v1, 4, 1
    v_lshlrev_b32 v22, 5, v22
    v_and_b32 v23, 3, v1
    v_lshlrev_b32 v23, 3, v23
    v_add_u32 v21, v21, v22
    v_add_u32 v20, v21, v23
    v_add_u32 v20, 101376, v20
    v_mov_b32 v64, 0
    v_mov_b32 v65, 0
    v_mov_b32 v66, 0
    v_mov_b32 v67, 0
    v_mov_b32 v68, 0
    v_mov_b32 v69, 0
    v_mov_b32 v70, 0
    v_mov_b32 v71, 0
    v_mov_b32 v72, 0
    v_mov_b32 v73, 0
    v_mov_b32 v74, 0
    v_mov_b32 v75, 0
    v_mov_b32 v76, 0
    v_mov_b32 v77, 0
    v_mov_b32 v78, 0
    v_mov_b32 v79, 0
    v_mov_b32 v80, 0
    v_mov_b32 v81, 0
    v_mov_b32 v82, 0
    v_mov_b32 v83, 0
    v_mov_b32 v84, 0
    v_mov_b32 v85, 0
    v_mov_b32 v86, 0
    v_mov_b32 v87, 0
    v_mov_b32 v88, 0
    v_mov_b32 v89, 0
    v_mov_b32 v90, 0
    v_mov_b32 v91, 0
    v_mov_b32 v92, 0
    v_mov_b32 v93, 0
    v_mov_b32 v94, 0
    v_mov_b32 v95, 0
    v_mov_b32 v96, 0
    v_mov_b32 v97, 0
    v_mov_b32 v98, 0
    v_mov_b32 v99, 0
    v_mov_b32 v100, 0
    v_mov_b32 v101, 0
    v_mov_b32 v102, 0
    v_mov_b32 v103, 0
    v_mov_b32 v104, 0
    v_mov_b32 v105, 0
    v_mov_b32 v106, 0
    v_mov_b32 v107, 0
    v_mov_b32 v108, 0
    v_mov_b32 v109, 0
    v_mov_b32 v110, 0
    v_mov_b32 v111, 0
    v_mov_b32 v112, 0
    v_mov_b32 v113, 0
    v_mov_b32 v114, 0
    v_mov_b32 v115, 0
    v_mov_b32 v116, 0
    v_mov_b32 v117, 0
    v_mov_b32 v118, 0
    v_mov_b32 v119, 0
    v_mov_b32 v120, 0
    v_mov_b32 v121, 0
    v_mov_b32 v122, 0
    v_mov_b32 v123, 0
    v_mov_b32 v124, 0
    v_mov_b32 v125, 0
    v_mov_b32 v126, 0
    v_mov_b32 v127, 0
    v_mov_b32 v128, 0
    v_mov_b32 v129, 0
    v_mov_b32 v130, 0
    v_mov_b32 v131, 0
    v_mov_b32 v132, 0
    v_mov_b32 v133, 0
    v_mov_b32 v134, 0
    v_mov_b32 v135, 0
    v_mov_b32 v136, 0
    v_mov_b32 v137, 0
    v_mov_b32 v138, 0
    v_mov_b32 v139, 0
    v_mov_b32 v140, 0
    v_mov_b32 v141, 0
    v_mov_b32 v142, 0
    v_mov_b32 v143, 0
    v_mov_b32 v144, 0
    v_mov_b32 v145, 0
    v_mov_b32 v146, 0
    v_mov_b32 v147, 0
    v_mov_b32 v148, 0
    v_mov_b32 v149, 0
    v_mov_b32 v150, 0
    v_mov_b32 v151, 0
    v_mov_b32 v152, 0
    v_mov_b32 v153, 0
    v_mov_b32 v154, 0
    v_mov_b32 v155, 0
    v_mov_b32 v156, 0
    v_mov_b32 v157, 0
    v_mov_b32 v158, 0
    v_mov_b32 v159, 0
    v_mov_b32 v160, 0
    v_mov_b32 v161, 0
    v_mov_b32 v162, 0
    v_mov_b32 v163, 0
    v_mov_b32 v164, 0
    v_mov_b32 v165, 0
    v_mov_b32 v166, 0
    v_mov_b32 v167, 0
    v_mov_b32 v168, 0
    v_mov_b32 v169, 0
    v_mov_b32 v170, 0
    v_mov_b32 v171, 0
    v_mov_b32 v172, 0
    v_mov_b32 v173, 0
    v_mov_b32 v174, 0
    v_mov_b32 v175, 0
    v_mov_b32 v176, 0
    v_mov_b32 v177, 0
    v_mov_b32 v178, 0
    v_mov_b32 v179, 0
    v_mov_b32 v180, 0
    v_mov_b32 v181, 0
    v_mov_b32 v182, 0
    v_mov_b32 v183, 0
    v_mov_b32 v184, 0
    v_mov_b32 v185, 0
    v_mov_b32 v186, 0
    v_mov_b32 v187, 0
    v_mov_b32 v188, 0
    v_mov_b32 v189, 0
    v_mov_b32 v190, 0
    v_mov_b32 v191, 0
    v_mov_b32 v192, 0
    v_mov_b32 v193, 0
    v_mov_b32 v194, 0
    v_mov_b32 v195, 0
    v_mov_b32 v196, 0
    v_mov_b32 v197, 0
    v_mov_b32 v198, 0
    v_mov_b32 v199, 0
    v_mov_b32 v200, 0
    v_mov_b32 v201, 0
    v_mov_b32 v202, 0
    v_mov_b32 v203, 0
    v_mov_b32 v204, 0
    v_mov_b32 v205, 0
    v_mov_b32 v206, 0
    v_mov_b32 v207, 0
    v_mov_b32 v208, 0
    v_mov_b32 v209, 0
    v_mov_b32 v210, 0
    v_mov_b32 v211, 0
    v_mov_b32 v212, 0
    v_mov_b32 v213, 0
    v_mov_b32 v214, 0
    v_mov_b32 v215, 0
    v_mov_b32 v216, 0
    v_mov_b32 v217, 0
    v_mov_b32 v218, 0
    v_mov_b32 v219, 0
    v_mov_b32 v220, 0
    v_mov_b32 v221, 0
    v_mov_b32 v222, 0
    v_mov_b32 v223, 0
    v_mov_b32 v224, 0
    v_mov_b32 v225, 0
    v_mov_b32 v226, 0
    v_mov_b32 v227, 0
    v_mov_b32 v228, 0
    v_mov_b32 v229, 0
    v_mov_b32 v230, 0
    v_mov_b32 v231, 0
    v_mov_b32 v232, 0
    v_mov_b32 v233, 0
    v_mov_b32 v234, 0
    v_mov_b32 v235, 0
    v_mov_b32 v236, 0
    v_mov_b32 v237, 0
    v_mov_b32 v238, 0
    v_mov_b32 v239, 0
    v_mov_b32 v240, 0
    v_mov_b32 v241, 0
    v_mov_b32 v242, 0
    v_mov_b32 v243, 0
    v_mov_b32 v244, 0
    v_mov_b32 v245, 0
    v_mov_b32 v246, 0
    v_mov_b32 v247, 0
    v_mov_b32 v248, 0
    v_mov_b32 v249, 0
    v_mov_b32 v250, 0
    v_mov_b32 v251, 0
    v_mov_b32 v252, 0
    v_mov_b32 v253, 0
    v_mov_b32 v254, 0
    v_mov_b32 v255, 0
    v_cmp_gt_u32 vcc, 32, v1
    v_mov_b32 v10, 0x7ffffff0
    s_cmp_lg_u32 s22, 0
    s_cbranch_scc1 L_parallel_sum__mha_block__glu_gated_bilinear__prompt_kernel_glu_pfw
    s_mul_i32 s56, s20, 327680
    s_add_u32 s52, s68, s56
    s_addc_u32 s53, s69, 0
    s_mov_b32 s54, 327680
    s_and_b32 s56, s21, 7
    s_lshl_b32 s56, s56, 5
    v_add_u32 v8, s56, v2
    v_mul_u32_u24 v8, 1280, v8
    s_mov_b32 s57, 128
    s_mov_b32 s58, 1280
    s_branch L_parallel_sum__mha_block__glu_gated_bilinear__prompt_kernel_glu_pfd
L_parallel_sum__mha_block__glu_gated_bilinear__prompt_kernel_glu_pfw:
    s_cmp_eq_u32 s22, 1
    s_cselect_b32 s52, s76, s78
    s_cselect_b32 s53, s77, s79
    s_sub_u32 s56, s21, 12
    s_mul_i32 s56, s56, 192
    s_and_b32 s56, s56, 0xffffff80
    s_mov_b32 s54, 2211840
    s_cmp_eq_u32 s22, 3
    s_cselect_b32 s54, 0, s54
    s_and_b32 s57, s20, 3
    s_mul_i32 s57, s57, 55296
    s_add_u32 s56, s56, s57
    v_lshrrev_b32 v8, 1, v1
    v_mul_u32_u24 v8, 3456, v8
    v_and_b32 v9, 1, v1
    v_lshlrev_b32 v9, 7, v9
    v_add3_u32 v8, v8, v9, s56
    s_mov_b32 s57, 221184
    s_mov_b32 s58, 0x7fffffff
L_parallel_sum__mha_block__glu_gated_bilinear__prompt_kernel_glu_pfd:
    v_cndmask_b32 v8, v10, v8, vcc
    s_mov_b32 s55, 0x20000
    s_mul_i32 s56, s57, 2
    buffer_load_dword v9, v8, s[52:55], s56 offen
    s_add_u32 s56, s56, s57
    buffer_load_dword v9, v8, s[52:55], s56 offen
    s_add_u32 s56, s56, s57
    s_barrier
    ds_read_b128 v[32:35], v4 offset:0
    ds_read_b128 v[36:39], v4 offset:4096
    ds_read_b64_tr_b16 v[48:49], v20 offset:0
    ds_read_b64_tr_b16 v[50:51], v20 offset:768
    ds_read_b64_tr_b16 v[52:53], v20 offset:64
    ds_read_b64_tr_b16 v[54:55], v20 offset:832
    ds_read_b64_tr_b16 v[56:57], v20 offset:128
    ds_read_b64_tr_b16 v[58:59], v20 offset:896
    s_mov_b32 s24, 0
    s_mov_b32 s25, 0
    s_mov_b32 s27, 0
L_parallel_sum__mha_block__glu_gated_bilinear__prompt_kernel_glu_loop:
    s_waitcnt lgkmcnt(4)
    v_mfma_f32_32x32x16_bf16 v[64:79], v[48:51], v[32:35], v[64:79]
    ds_read_b64_tr_b16 v[60:61], v20 offset:6144
    ds_read_b64_tr_b16 v[62:63], v20 offset:6912
    s_add_u32 s25, s25, 1
    s_cmp_eq_u32 s25, 5
    s_cselect_b32 s25, 0, s25
    s_mov_b32 s26, 12288
    s_cselect_b32 s26, 4294918144, s26
    v_mfma_f32_32x32x16_bf16 v[160:175], v[48:51], v[36:39], v[160:175]
    s_add_u32 s27, s27, 1
    s_cmp_eq_u32 s27, 3
    s_cselect_b32 s27, 0, s27
    s_mov_b32 s28, 32768
    s_cselect_b32 s28, 4294901760, s28
    s_waitcnt lgkmcnt(4)
    v_mfma_f32_32x32x16_bf16 v[80:95], v[52:55], v[32:35], v[80:95]
    ds_read_b64_tr_b16 v[48:49], v20 offset:6208
    ds_read_b64_tr_b16 v[50:51], v20 offset:6976
    v_mfma_f32_32x32x16_bf16 v[176:191], v[52:55], v[36:39], v[176:191]
    ds_read_b128 v[40:43], v5 offset:0
    ds_read_b128 v[44:47], v5 offset:4096
    s_waitcnt lgkmcnt(6)
    v_mfma_f32_32x32x16_bf16 v[96:111], v[56:59], v[32:35], v[96:111]
    ds_read_b64_tr_b16 v[52:53], v20 offset:6272
    ds_read_b64_tr_b16 v[54:55], v20 offset:7040
    v_mfma_f32_32x32x16_bf16 v[192:207], v[56:59], v[36:39], v[192:207]
    v_add_u32 v4, s28, v4
    s_waitcnt lgkmcnt(6)
    v_mfma_f32_32x32x16_bf16 v[112:127], v[60:63], v[32:35], v[112:127]
    ds_read_b64_tr_b16 v[56:57], v20 offset:3072
    ds_read_b64_tr_b16 v[58:59], v20 offset:3840
    v_mfma_f32_32x32x16_bf16 v[208:223], v[60:63], v[36:39], v[208:223]
    v_add_u32 v5, s28, v5
    s_waitcnt lgkmcnt(6)
    v_mfma_f32_32x32x16_bf16 v[128:143], v[48:51], v[32:35], v[128:143]
    ds_read_b64_tr_b16 v[60:61], v20 offset:3136
    ds_read_b64_tr_b16 v[62:63], v20 offset:3904
    s_cmp_lt_u32 s56, s58
    s_cselect_b32 s59, s56, 0x0ffffff0
    v_mfma_f32_32x32x16_bf16 v[224:239], v[48:51], v[36:39], v[224:239]
    buffer_load_dword v9, v8, s[52:55], s59 offen
    s_add_u32 s56, s56, s57
    s_waitcnt lgkmcnt(4)
    v_mfma_f32_32x32x16_bf16 v[144:159], v[52:55], v[32:35], v[144:159]
    ds_read_b64_tr_b16 v[48:49], v20 offset:3200
    ds_read_b64_tr_b16 v[50:51], v20 offset:3968
    v_mfma_f32_32x32x16_bf16 v[240:255], v[52:55], v[36:39], v[240:255]
    s_waitcnt lgkmcnt(4)
    v_mfma_f32_32x32x16_bf16 v[64:79], v[56:59], v[40:43], v[64:79]
    ds_read_b64_tr_b16 v[52:53], v20 offset:9216
    ds_read_b64_tr_b16 v[54:55], v20 offset:9984
    v_mfma_f32_32x32x16_bf16 v[160:175], v[56:59], v[44:47], v[160:175]
    s_waitcnt lgkmcnt(4)
    v_mfma_f32_32x32x16_bf16 v[80:95], v[60:63], v[40:43], v[80:95]
    ds_read_b64_tr_b16 v[56:57], v20 offset:9280
    ds_read_b64_tr_b16 v[58:59], v20 offset:10048
    v_mfma_f32_32x32x16_bf16 v[176:191], v[60:63], v[44:47], v[176:191]
    s_waitcnt lgkmcnt(4)
    v_mfma_f32_32x32x16_bf16 v[96:111], v[48:51], v[40:43], v[96:111]
    ds_read_b64_tr_b16 v[60:61], v20 offset:9344
    ds_read_b64_tr_b16 v[62:63], v20 offset:10112
    v_mfma_f32_32x32x16_bf16 v[192:207], v[48:51], v[44:47], v[192:207]
    s_waitcnt lgkmcnt(4)
    v_mfma_f32_32x32x16_bf16 v[112:127], v[52:55], v[40:43], v[112:127]
    s_barrier
    v_add_u32 v20, s26, v20
    ds_read_b64_tr_b16 v[48:49], v20 offset:0
    ds_read_b64_tr_b16 v[50:51], v20 offset:768
    v_mfma_f32_32x32x16_bf16 v[208:223], v[52:55], v[44:47], v[208:223]
    ds_read_b128 v[32:35], v6 offset:0
    ds_read_b128 v[36:39], v6 offset:4096
    s_waitcnt lgkmcnt(6)
    v_mfma_f32_32x32x16_bf16 v[128:143], v[56:59], v[40:43], v[128:143]
    ds_read_b64_tr_b16 v[52:53], v20 offset:64
    ds_read_b64_tr_b16 v[54:55], v20 offset:832
    v_mfma_f32_32x32x16_bf16 v[224:239], v[56:59], v[44:47], v[224:239]
    s_waitcnt lgkmcnt(6)
    v_mfma_f32_32x32x16_bf16 v[144:159], v[60:63], v[40:43], v[144:159]
    ds_read_b64_tr_b16 v[56:57], v20 offset:128
    ds_read_b64_tr_b16 v[58:59], v20 offset:896
    v_mfma_f32_32x32x16_bf16 v[240:255], v[60:63], v[44:47], v[240:255]
    s_waitcnt lgkmcnt(4)
    v_mfma_f32_32x32x16_bf16 v[64:79], v[48:51], v[32:35], v[64:79]
    ds_read_b64_tr_b16 v[60:61], v20 offset:6144
    ds_read_b64_tr_b16 v[62:63], v20 offset:6912
    s_add_u32 s25, s25, 1
    s_cmp_eq_u32 s25, 5
    v_mfma_f32_32x32x16_bf16 v[160:175], v[48:51], v[36:39], v[160:175]
    s_cselect_b32 s25, 0, s25
    s_mov_b32 s26, 12288
    s_cselect_b32 s26, 4294918144, s26
    s_waitcnt lgkmcnt(4)
    v_mfma_f32_32x32x16_bf16 v[80:95], v[52:55], v[32:35], v[80:95]
    ds_read_b64_tr_b16 v[48:49], v20 offset:6208
    ds_read_b64_tr_b16 v[50:51], v20 offset:6976
    v_mfma_f32_32x32x16_bf16 v[176:191], v[52:55], v[36:39], v[176:191]
    ds_read_b128 v[40:43], v7 offset:0
    ds_read_b128 v[44:47], v7 offset:4096
    s_waitcnt lgkmcnt(6)
    v_mfma_f32_32x32x16_bf16 v[96:111], v[56:59], v[32:35], v[96:111]
    ds_read_b64_tr_b16 v[52:53], v20 offset:6272
    ds_read_b64_tr_b16 v[54:55], v20 offset:7040
    v_mfma_f32_32x32x16_bf16 v[192:207], v[56:59], v[36:39], v[192:207]
    v_add_u32 v6, s28, v6
    s_waitcnt lgkmcnt(6)
    v_mfma_f32_32x32x16_bf16 v[112:127], v[60:63], v[32:35], v[112:127]
    ds_read_b64_tr_b16 v[56:57], v20 offset:3072
    ds_read_b64_tr_b16 v[58:59], v20 offset:3840
    v_mfma_f32_32x32x16_bf16 v[208:223], v[60:63], v[36:39], v[208:223]
    v_add_u32 v7, s28, v7
    s_waitcnt lgkmcnt(6)
    v_mfma_f32_32x32x16_bf16 v[128:143], v[48:51], v[32:35], v[128:143]
    ds_read_b64_tr_b16 v[60:61], v20 offset:3136
    ds_read_b64_tr_b16 v[62:63], v20 offset:3904
    v_mfma_f32_32x32x16_bf16 v[224:239], v[48:51], v[36:39], v[224:239]
    s_waitcnt lgkmcnt(4)
    v_mfma_f32_32x32x16_bf16 v[144:159], v[52:55], v[32:35], v[144:159]
    ds_read_b64_tr_b16 v[48:49], v20 offset:3200
    ds_read_b64_tr_b16 v[50:51], v20 offset:3968
    v_mfma_f32_32x32x16_bf16 v[240:255], v[52:55], v[36:39], v[240:255]
    s_waitcnt lgkmcnt(4)
    v_mfma_f32_32x32x16_bf16 v[64:79], v[56:59], v[40:43], v[64:79]
    ds_read_b64_tr_b16 v[52:53], v20 offset:9216
    ds_read_b64_tr_b16 v[54:55], v20 offset:9984
    v_mfma_f32_32x32x16_bf16 v[160:175], v[56:59], v[44:47], v[160:175]
    s_waitcnt lgkmcnt(4)
    v_mfma_f32_32x32x16_bf16 v[80:95], v[60:63], v[40:43], v[80:95]
    ds_read_b64_tr_b16 v[56:57], v20 offset:9280
    ds_read_b64_tr_b16 v[58:59], v20 offset:10048
    v_mfma_f32_32x32x16_bf16 v[176:191], v[60:63], v[44:47], v[176:191]
    s_waitcnt lgkmcnt(4)
    v_mfma_f32_32x32x16_bf16 v[96:111], v[48:51], v[40:43], v[96:111]
    ds_read_b64_tr_b16 v[60:61], v20 offset:9344
    ds_read_b64_tr_b16 v[62:63], v20 offset:10112
    v_mfma_f32_32x32x16_bf16 v[192:207], v[48:51], v[44:47], v[192:207]
    s_waitcnt lgkmcnt(4)
    v_mfma_f32_32x32x16_bf16 v[112:127], v[52:55], v[40:43], v[112:127]
    s_barrier
    v_add_u32 v20, s26, v20
    ds_read_b64_tr_b16 v[48:49], v20 offset:0
    ds_read_b64_tr_b16 v[50:51], v20 offset:768
    v_mfma_f32_32x32x16_bf16 v[208:223], v[52:55], v[44:47], v[208:223]
    ds_read_b128 v[32:35], v4 offset:0
    ds_read_b128 v[36:39], v4 offset:4096
    s_waitcnt lgkmcnt(6)
    v_mfma_f32_32x32x16_bf16 v[128:143], v[56:59], v[40:43], v[128:143]
    ds_read_b64_tr_b16 v[52:53], v20 offset:64
    ds_read_b64_tr_b16 v[54:55], v20 offset:832
    v_mfma_f32_32x32x16_bf16 v[224:239], v[56:59], v[44:47], v[224:239]
    s_waitcnt lgkmcnt(6)
    v_mfma_f32_32x32x16_bf16 v[144:159], v[60:63], v[40:43], v[144:159]
    ds_read_b64_tr_b16 v[56:57], v20 offset:128
    ds_read_b64_tr_b16 v[58:59], v20 offset:896
    v_mfma_f32_32x32x16_bf16 v[240:255], v[60:63], v[44:47], v[240:255]
    s_add_u32 s24, s24, 1
    s_cmp_lt_u32 s24, 10
    s_cbranch_scc1 L_parallel_sum__mha_block__glu_gated_bilinear__prompt_kernel_glu_loop
    s_waitcnt vmcnt(0) lgkmcnt(0)
    s_nop 15
    v_add_u32 v10, s23, v2
    v_lshlrev_b32 v10, 2, v10
    ds_read_b32 v12, v10 offset:0
    ds_read_b32 v16, v10 offset:1024
    v_add_u32 v10, s23, v2
    v_lshlrev_b32 v10, 2, v10
    ds_read_b32 v14, v10 offset:128
    ds_read_b32 v18, v10 offset:1152
    v_lshlrev_b32 v11, 4, v3
    s_sub_u32 s34, s21, 12
    s_mul_i32 s34, s34, 6144
    s_lshl_b32 s35, s20, 3
    s_lshl_b32 s36, s22, 1
    s_add_u32 s35, s35, s36
    s_mul_i32 s35, s35, 110592
    s_add_u32 s33, s34, s35
    s_add_u32 s33, s33, 7864320
    v_lshlrev_b32 v20, 4, v1
    s_waitcnt lgkmcnt(0)
    v_sub_f32 v12, 0, v12
    v_sub_f32 v14, 0, v14
    v_mul_f32 v16, v16, v16
    v_mul_f32 v18, v18, v18
    ds_read_b128 v[32:35], v11 offset:2048
    ds_read_b128 v[48:51], v11 offset:2432
    ds_read_b128 v[36:39], v11 offset:2080
    ds_read_b128 v[52:55], v11 offset:2464
    ds_read_b128 v[40:43], v11 offset:2112
    ds_read_b128 v[56:59], v11 offset:2496
    ds_read_b128 v[44:47], v11 offset:2144
    ds_read_b128 v[60:63], v11 offset:2528
    s_waitcnt lgkmcnt(0)
    v_pk_fma_f32 v[64:65], v[32:33], v[12:13], v[64:65] op_sel_hi:[1,0,1]
    v_pk_fma_f32 v[112:113], v[48:49], v[12:13], v[112:113] op_sel_hi:[1,0,1]
    v_pk_fma_f32 v[66:67], v[34:35], v[12:13], v[66:67] op_sel_hi:[1,0,1]
    v_pk_fma_f32 v[114:115], v[50:51], v[12:13], v[114:115] op_sel_hi:[1,0,1]
    v_pk_fma_f32 v[68:69], v[36:37], v[12:13], v[68:69] op_sel_hi:[1,0,1]
    v_pk_fma_f32 v[116:117], v[52:53], v[12:13], v[116:117] op_sel_hi:[1,0,1]
    v_pk_fma_f32 v[70:71], v[38:39], v[12:13], v[70:71] op_sel_hi:[1,0,1]
    v_pk_fma_f32 v[118:119], v[54:55], v[12:13], v[118:119] op_sel_hi:[1,0,1]
    v_pk_fma_f32 v[72:73], v[40:41], v[12:13], v[72:73] op_sel_hi:[1,0,1]
    v_pk_fma_f32 v[120:121], v[56:57], v[12:13], v[120:121] op_sel_hi:[1,0,1]
    v_pk_fma_f32 v[74:75], v[42:43], v[12:13], v[74:75] op_sel_hi:[1,0,1]
    v_pk_fma_f32 v[122:123], v[58:59], v[12:13], v[122:123] op_sel_hi:[1,0,1]
    v_pk_fma_f32 v[76:77], v[44:45], v[12:13], v[76:77] op_sel_hi:[1,0,1]
    v_pk_fma_f32 v[124:125], v[60:61], v[12:13], v[124:125] op_sel_hi:[1,0,1]
    v_pk_fma_f32 v[78:79], v[46:47], v[12:13], v[78:79] op_sel_hi:[1,0,1]
    v_pk_fma_f32 v[126:127], v[62:63], v[12:13], v[126:127] op_sel_hi:[1,0,1]
    v_pk_mul_f32 v[64:65], v[64:65], v[16:17] op_sel_hi:[1,0]
    v_pk_mul_f32 v[66:67], v[66:67], v[16:17] op_sel_hi:[1,0]
    v_pk_mul_f32 v[68:69], v[68:69], v[16:17] op_sel_hi:[1,0]
    v_pk_mul_f32 v[70:71], v[70:71], v[16:17] op_sel_hi:[1,0]
    v_pk_mul_f32 v[72:73], v[72:73], v[16:17] op_sel_hi:[1,0]
    v_pk_mul_f32 v[74:75], v[74:75], v[16:17] op_sel_hi:[1,0]
    v_pk_mul_f32 v[76:77], v[76:77], v[16:17] op_sel_hi:[1,0]
    v_pk_mul_f32 v[78:79], v[78:79], v[16:17] op_sel_hi:[1,0]
    v_pk_mul_f32 v[64:65], v[64:65], v[112:113]
    v_pk_mul_f32 v[66:67], v[66:67], v[114:115]
    v_pk_mul_f32 v[68:69], v[68:69], v[116:117]
    v_pk_mul_f32 v[70:71], v[70:71], v[118:119]
    v_pk_mul_f32 v[72:73], v[72:73], v[120:121]
    v_pk_mul_f32 v[74:75], v[74:75], v[122:123]
    v_pk_mul_f32 v[76:77], v[76:77], v[124:125]
    v_pk_mul_f32 v[78:79], v[78:79], v[126:127]
    v_cvt_pk_bf16_f32 v112, v64, v65
    v_cvt_pk_bf16_f32 v113, v66, v67
    v_cvt_pk_bf16_f32 v114, v68, v69
    v_cvt_pk_bf16_f32 v115, v70, v71
    s_add_u32 s36, s33, 0
    buffer_store_dwordx4 v[112:115], v20, s[16:19], s36 offen sc0 sc1
    v_cvt_pk_bf16_f32 v120, v72, v73
    v_cvt_pk_bf16_f32 v121, v74, v75
    v_cvt_pk_bf16_f32 v122, v76, v77
    v_cvt_pk_bf16_f32 v123, v78, v79
    s_add_u32 s36, s33, 1024
    buffer_store_dwordx4 v[120:123], v20, s[16:19], s36 offen sc0 sc1
    v_pk_fma_f32 v[160:161], v[32:33], v[14:15], v[160:161] op_sel_hi:[1,0,1]
    v_pk_fma_f32 v[208:209], v[48:49], v[14:15], v[208:209] op_sel_hi:[1,0,1]
    v_pk_fma_f32 v[162:163], v[34:35], v[14:15], v[162:163] op_sel_hi:[1,0,1]
    v_pk_fma_f32 v[210:211], v[50:51], v[14:15], v[210:211] op_sel_hi:[1,0,1]
    v_pk_fma_f32 v[164:165], v[36:37], v[14:15], v[164:165] op_sel_hi:[1,0,1]
    v_pk_fma_f32 v[212:213], v[52:53], v[14:15], v[212:213] op_sel_hi:[1,0,1]
    v_pk_fma_f32 v[166:167], v[38:39], v[14:15], v[166:167] op_sel_hi:[1,0,1]
    v_pk_fma_f32 v[214:215], v[54:55], v[14:15], v[214:215] op_sel_hi:[1,0,1]
    v_pk_fma_f32 v[168:169], v[40:41], v[14:15], v[168:169] op_sel_hi:[1,0,1]
    v_pk_fma_f32 v[216:217], v[56:57], v[14:15], v[216:217] op_sel_hi:[1,0,1]
    v_pk_fma_f32 v[170:171], v[42:43], v[14:15], v[170:171] op_sel_hi:[1,0,1]
    v_pk_fma_f32 v[218:219], v[58:59], v[14:15], v[218:219] op_sel_hi:[1,0,1]
    v_pk_fma_f32 v[172:173], v[44:45], v[14:15], v[172:173] op_sel_hi:[1,0,1]
    v_pk_fma_f32 v[220:221], v[60:61], v[14:15], v[220:221] op_sel_hi:[1,0,1]
    v_pk_fma_f32 v[174:175], v[46:47], v[14:15], v[174:175] op_sel_hi:[1,0,1]
    v_pk_fma_f32 v[222:223], v[62:63], v[14:15], v[222:223] op_sel_hi:[1,0,1]
    v_pk_mul_f32 v[160:161], v[160:161], v[18:19] op_sel_hi:[1,0]
    v_pk_mul_f32 v[162:163], v[162:163], v[18:19] op_sel_hi:[1,0]
    v_pk_mul_f32 v[164:165], v[164:165], v[18:19] op_sel_hi:[1,0]
    v_pk_mul_f32 v[166:167], v[166:167], v[18:19] op_sel_hi:[1,0]
    v_pk_mul_f32 v[168:169], v[168:169], v[18:19] op_sel_hi:[1,0]
    v_pk_mul_f32 v[170:171], v[170:171], v[18:19] op_sel_hi:[1,0]
    v_pk_mul_f32 v[172:173], v[172:173], v[18:19] op_sel_hi:[1,0]
    v_pk_mul_f32 v[174:175], v[174:175], v[18:19] op_sel_hi:[1,0]
    v_pk_mul_f32 v[160:161], v[160:161], v[208:209]
    v_pk_mul_f32 v[162:163], v[162:163], v[210:211]
    v_pk_mul_f32 v[164:165], v[164:165], v[212:213]
    v_pk_mul_f32 v[166:167], v[166:167], v[214:215]
    v_pk_mul_f32 v[168:169], v[168:169], v[216:217]
    v_pk_mul_f32 v[170:171], v[170:171], v[218:219]
    v_pk_mul_f32 v[172:173], v[172:173], v[220:221]
    v_pk_mul_f32 v[174:175], v[174:175], v[222:223]
    v_cvt_pk_bf16_f32 v208, v160, v161
    v_cvt_pk_bf16_f32 v209, v162, v163
    v_cvt_pk_bf16_f32 v210, v164, v165
    v_cvt_pk_bf16_f32 v211, v166, v167
    s_add_u32 s36, s33, 110592
    buffer_store_dwordx4 v[208:211], v20, s[16:19], s36 offen sc0 sc1
    v_cvt_pk_bf16_f32 v216, v168, v169
    v_cvt_pk_bf16_f32 v217, v170, v171
    v_cvt_pk_bf16_f32 v218, v172, v173
    v_cvt_pk_bf16_f32 v219, v174, v175
    s_add_u32 s36, s33, 111616
    buffer_store_dwordx4 v[216:219], v20, s[16:19], s36 offen sc0 sc1
    ds_read_b128 v[32:35], v11 offset:2176
    ds_read_b128 v[48:51], v11 offset:2560
    ds_read_b128 v[36:39], v11 offset:2208
    ds_read_b128 v[52:55], v11 offset:2592
    ds_read_b128 v[40:43], v11 offset:2240
    ds_read_b128 v[56:59], v11 offset:2624
    ds_read_b128 v[44:47], v11 offset:2272
    ds_read_b128 v[60:63], v11 offset:2656
    s_waitcnt lgkmcnt(0)
    v_pk_fma_f32 v[80:81], v[32:33], v[12:13], v[80:81] op_sel_hi:[1,0,1]
    v_pk_fma_f32 v[128:129], v[48:49], v[12:13], v[128:129] op_sel_hi:[1,0,1]
    v_pk_fma_f32 v[82:83], v[34:35], v[12:13], v[82:83] op_sel_hi:[1,0,1]
    v_pk_fma_f32 v[130:131], v[50:51], v[12:13], v[130:131] op_sel_hi:[1,0,1]
    v_pk_fma_f32 v[84:85], v[36:37], v[12:13], v[84:85] op_sel_hi:[1,0,1]
    v_pk_fma_f32 v[132:133], v[52:53], v[12:13], v[132:133] op_sel_hi:[1,0,1]
    v_pk_fma_f32 v[86:87], v[38:39], v[12:13], v[86:87] op_sel_hi:[1,0,1]
    v_pk_fma_f32 v[134:135], v[54:55], v[12:13], v[134:135] op_sel_hi:[1,0,1]
    v_pk_fma_f32 v[88:89], v[40:41], v[12:13], v[88:89] op_sel_hi:[1,0,1]
    v_pk_fma_f32 v[136:137], v[56:57], v[12:13], v[136:137] op_sel_hi:[1,0,1]
    v_pk_fma_f32 v[90:91], v[42:43], v[12:13], v[90:91] op_sel_hi:[1,0,1]
    v_pk_fma_f32 v[138:139], v[58:59], v[12:13], v[138:139] op_sel_hi:[1,0,1]
    v_pk_fma_f32 v[92:93], v[44:45], v[12:13], v[92:93] op_sel_hi:[1,0,1]
    v_pk_fma_f32 v[140:141], v[60:61], v[12:13], v[140:141] op_sel_hi:[1,0,1]
    v_pk_fma_f32 v[94:95], v[46:47], v[12:13], v[94:95] op_sel_hi:[1,0,1]
    v_pk_fma_f32 v[142:143], v[62:63], v[12:13], v[142:143] op_sel_hi:[1,0,1]
    v_pk_mul_f32 v[80:81], v[80:81], v[16:17] op_sel_hi:[1,0]
    v_pk_mul_f32 v[82:83], v[82:83], v[16:17] op_sel_hi:[1,0]
    v_pk_mul_f32 v[84:85], v[84:85], v[16:17] op_sel_hi:[1,0]
    v_pk_mul_f32 v[86:87], v[86:87], v[16:17] op_sel_hi:[1,0]
    v_pk_mul_f32 v[88:89], v[88:89], v[16:17] op_sel_hi:[1,0]
    v_pk_mul_f32 v[90:91], v[90:91], v[16:17] op_sel_hi:[1,0]
    v_pk_mul_f32 v[92:93], v[92:93], v[16:17] op_sel_hi:[1,0]
    v_pk_mul_f32 v[94:95], v[94:95], v[16:17] op_sel_hi:[1,0]
    v_pk_mul_f32 v[80:81], v[80:81], v[128:129]
    v_pk_mul_f32 v[82:83], v[82:83], v[130:131]
    v_pk_mul_f32 v[84:85], v[84:85], v[132:133]
    v_pk_mul_f32 v[86:87], v[86:87], v[134:135]
    v_pk_mul_f32 v[88:89], v[88:89], v[136:137]
    v_pk_mul_f32 v[90:91], v[90:91], v[138:139]
    v_pk_mul_f32 v[92:93], v[92:93], v[140:141]
    v_pk_mul_f32 v[94:95], v[94:95], v[142:143]
    v_cvt_pk_bf16_f32 v128, v80, v81
    v_cvt_pk_bf16_f32 v129, v82, v83
    v_cvt_pk_bf16_f32 v130, v84, v85
    v_cvt_pk_bf16_f32 v131, v86, v87
    s_add_u32 s36, s33, 2048
    buffer_store_dwordx4 v[128:131], v20, s[16:19], s36 offen sc0 sc1
    v_cvt_pk_bf16_f32 v136, v88, v89
    v_cvt_pk_bf16_f32 v137, v90, v91
    v_cvt_pk_bf16_f32 v138, v92, v93
    v_cvt_pk_bf16_f32 v139, v94, v95
    s_add_u32 s36, s33, 3072
    buffer_store_dwordx4 v[136:139], v20, s[16:19], s36 offen sc0 sc1
    v_pk_fma_f32 v[176:177], v[32:33], v[14:15], v[176:177] op_sel_hi:[1,0,1]
    v_pk_fma_f32 v[224:225], v[48:49], v[14:15], v[224:225] op_sel_hi:[1,0,1]
    v_pk_fma_f32 v[178:179], v[34:35], v[14:15], v[178:179] op_sel_hi:[1,0,1]
    v_pk_fma_f32 v[226:227], v[50:51], v[14:15], v[226:227] op_sel_hi:[1,0,1]
    v_pk_fma_f32 v[180:181], v[36:37], v[14:15], v[180:181] op_sel_hi:[1,0,1]
    v_pk_fma_f32 v[228:229], v[52:53], v[14:15], v[228:229] op_sel_hi:[1,0,1]
    v_pk_fma_f32 v[182:183], v[38:39], v[14:15], v[182:183] op_sel_hi:[1,0,1]
    v_pk_fma_f32 v[230:231], v[54:55], v[14:15], v[230:231] op_sel_hi:[1,0,1]
    v_pk_fma_f32 v[184:185], v[40:41], v[14:15], v[184:185] op_sel_hi:[1,0,1]
    v_pk_fma_f32 v[232:233], v[56:57], v[14:15], v[232:233] op_sel_hi:[1,0,1]
    v_pk_fma_f32 v[186:187], v[42:43], v[14:15], v[186:187] op_sel_hi:[1,0,1]
    v_pk_fma_f32 v[234:235], v[58:59], v[14:15], v[234:235] op_sel_hi:[1,0,1]
    v_pk_fma_f32 v[188:189], v[44:45], v[14:15], v[188:189] op_sel_hi:[1,0,1]
    v_pk_fma_f32 v[236:237], v[60:61], v[14:15], v[236:237] op_sel_hi:[1,0,1]
    v_pk_fma_f32 v[190:191], v[46:47], v[14:15], v[190:191] op_sel_hi:[1,0,1]
    v_pk_fma_f32 v[238:239], v[62:63], v[14:15], v[238:239] op_sel_hi:[1,0,1]
    v_pk_mul_f32 v[176:177], v[176:177], v[18:19] op_sel_hi:[1,0]
    v_pk_mul_f32 v[178:179], v[178:179], v[18:19] op_sel_hi:[1,0]
    v_pk_mul_f32 v[180:181], v[180:181], v[18:19] op_sel_hi:[1,0]
    v_pk_mul_f32 v[182:183], v[182:183], v[18:19] op_sel_hi:[1,0]
    v_pk_mul_f32 v[184:185], v[184:185], v[18:19] op_sel_hi:[1,0]
    v_pk_mul_f32 v[186:187], v[186:187], v[18:19] op_sel_hi:[1,0]
    v_pk_mul_f32 v[188:189], v[188:189], v[18:19] op_sel_hi:[1,0]
    v_pk_mul_f32 v[190:191], v[190:191], v[18:19] op_sel_hi:[1,0]
    v_pk_mul_f32 v[176:177], v[176:177], v[224:225]
    v_pk_mul_f32 v[178:179], v[178:179], v[226:227]
    v_pk_mul_f32 v[180:181], v[180:181], v[228:229]
    v_pk_mul_f32 v[182:183], v[182:183], v[230:231]
    v_pk_mul_f32 v[184:185], v[184:185], v[232:233]
    v_pk_mul_f32 v[186:187], v[186:187], v[234:235]
    v_pk_mul_f32 v[188:189], v[188:189], v[236:237]
    v_pk_mul_f32 v[190:191], v[190:191], v[238:239]
    v_cvt_pk_bf16_f32 v224, v176, v177
    v_cvt_pk_bf16_f32 v225, v178, v179
    v_cvt_pk_bf16_f32 v226, v180, v181
    v_cvt_pk_bf16_f32 v227, v182, v183
    s_add_u32 s36, s33, 112640
    buffer_store_dwordx4 v[224:227], v20, s[16:19], s36 offen sc0 sc1
    v_cvt_pk_bf16_f32 v232, v184, v185
    v_cvt_pk_bf16_f32 v233, v186, v187
    v_cvt_pk_bf16_f32 v234, v188, v189
    v_cvt_pk_bf16_f32 v235, v190, v191
    s_add_u32 s36, s33, 113664
    buffer_store_dwordx4 v[232:235], v20, s[16:19], s36 offen sc0 sc1
    ds_read_b128 v[32:35], v11 offset:2304
    ds_read_b128 v[48:51], v11 offset:2688
    ds_read_b128 v[36:39], v11 offset:2336
    ds_read_b128 v[52:55], v11 offset:2720
    ds_read_b128 v[40:43], v11 offset:2368
    ds_read_b128 v[56:59], v11 offset:2752
    ds_read_b128 v[44:47], v11 offset:2400
    ds_read_b128 v[60:63], v11 offset:2784
    s_waitcnt lgkmcnt(0)
    v_pk_fma_f32 v[96:97], v[32:33], v[12:13], v[96:97] op_sel_hi:[1,0,1]
    v_pk_fma_f32 v[144:145], v[48:49], v[12:13], v[144:145] op_sel_hi:[1,0,1]
    v_pk_fma_f32 v[98:99], v[34:35], v[12:13], v[98:99] op_sel_hi:[1,0,1]
    v_pk_fma_f32 v[146:147], v[50:51], v[12:13], v[146:147] op_sel_hi:[1,0,1]
    v_pk_fma_f32 v[100:101], v[36:37], v[12:13], v[100:101] op_sel_hi:[1,0,1]
    v_pk_fma_f32 v[148:149], v[52:53], v[12:13], v[148:149] op_sel_hi:[1,0,1]
    v_pk_fma_f32 v[102:103], v[38:39], v[12:13], v[102:103] op_sel_hi:[1,0,1]
    v_pk_fma_f32 v[150:151], v[54:55], v[12:13], v[150:151] op_sel_hi:[1,0,1]
    v_pk_fma_f32 v[104:105], v[40:41], v[12:13], v[104:105] op_sel_hi:[1,0,1]
    v_pk_fma_f32 v[152:153], v[56:57], v[12:13], v[152:153] op_sel_hi:[1,0,1]
    v_pk_fma_f32 v[106:107], v[42:43], v[12:13], v[106:107] op_sel_hi:[1,0,1]
    v_pk_fma_f32 v[154:155], v[58:59], v[12:13], v[154:155] op_sel_hi:[1,0,1]
    v_pk_fma_f32 v[108:109], v[44:45], v[12:13], v[108:109] op_sel_hi:[1,0,1]
    v_pk_fma_f32 v[156:157], v[60:61], v[12:13], v[156:157] op_sel_hi:[1,0,1]
    v_pk_fma_f32 v[110:111], v[46:47], v[12:13], v[110:111] op_sel_hi:[1,0,1]
    v_pk_fma_f32 v[158:159], v[62:63], v[12:13], v[158:159] op_sel_hi:[1,0,1]
    v_pk_mul_f32 v[96:97], v[96:97], v[16:17] op_sel_hi:[1,0]
    v_pk_mul_f32 v[98:99], v[98:99], v[16:17] op_sel_hi:[1,0]
    v_pk_mul_f32 v[100:101], v[100:101], v[16:17] op_sel_hi:[1,0]
    v_pk_mul_f32 v[102:103], v[102:103], v[16:17] op_sel_hi:[1,0]
    v_pk_mul_f32 v[104:105], v[104:105], v[16:17] op_sel_hi:[1,0]
    v_pk_mul_f32 v[106:107], v[106:107], v[16:17] op_sel_hi:[1,0]
    v_pk_mul_f32 v[108:109], v[108:109], v[16:17] op_sel_hi:[1,0]
    v_pk_mul_f32 v[110:111], v[110:111], v[16:17] op_sel_hi:[1,0]
    v_pk_mul_f32 v[96:97], v[96:97], v[144:145]
    v_pk_mul_f32 v[98:99], v[98:99], v[146:147]
    v_pk_mul_f32 v[100:101], v[100:101], v[148:149]
    v_pk_mul_f32 v[102:103], v[102:103], v[150:151]
    v_pk_mul_f32 v[104:105], v[104:105], v[152:153]
    v_pk_mul_f32 v[106:107], v[106:107], v[154:155]
    v_pk_mul_f32 v[108:109], v[108:109], v[156:157]
    v_pk_mul_f32 v[110:111], v[110:111], v[158:159]
    v_cvt_pk_bf16_f32 v144, v96, v97
    v_cvt_pk_bf16_f32 v145, v98, v99
    v_cvt_pk_bf16_f32 v146, v100, v101
    v_cvt_pk_bf16_f32 v147, v102, v103
    s_add_u32 s36, s33, 4096
    buffer_store_dwordx4 v[144:147], v20, s[16:19], s36 offen sc0 sc1
    v_cvt_pk_bf16_f32 v152, v104, v105
    v_cvt_pk_bf16_f32 v153, v106, v107
    v_cvt_pk_bf16_f32 v154, v108, v109
    v_cvt_pk_bf16_f32 v155, v110, v111
    s_add_u32 s36, s33, 5120
    buffer_store_dwordx4 v[152:155], v20, s[16:19], s36 offen sc0 sc1
    v_pk_fma_f32 v[192:193], v[32:33], v[14:15], v[192:193] op_sel_hi:[1,0,1]
    v_pk_fma_f32 v[240:241], v[48:49], v[14:15], v[240:241] op_sel_hi:[1,0,1]
    v_pk_fma_f32 v[194:195], v[34:35], v[14:15], v[194:195] op_sel_hi:[1,0,1]
    v_pk_fma_f32 v[242:243], v[50:51], v[14:15], v[242:243] op_sel_hi:[1,0,1]
    v_pk_fma_f32 v[196:197], v[36:37], v[14:15], v[196:197] op_sel_hi:[1,0,1]
    v_pk_fma_f32 v[244:245], v[52:53], v[14:15], v[244:245] op_sel_hi:[1,0,1]
    v_pk_fma_f32 v[198:199], v[38:39], v[14:15], v[198:199] op_sel_hi:[1,0,1]
    v_pk_fma_f32 v[246:247], v[54:55], v[14:15], v[246:247] op_sel_hi:[1,0,1]
    v_pk_fma_f32 v[200:201], v[40:41], v[14:15], v[200:201] op_sel_hi:[1,0,1]
    v_pk_fma_f32 v[248:249], v[56:57], v[14:15], v[248:249] op_sel_hi:[1,0,1]
    v_pk_fma_f32 v[202:203], v[42:43], v[14:15], v[202:203] op_sel_hi:[1,0,1]
    v_pk_fma_f32 v[250:251], v[58:59], v[14:15], v[250:251] op_sel_hi:[1,0,1]
    v_pk_fma_f32 v[204:205], v[44:45], v[14:15], v[204:205] op_sel_hi:[1,0,1]
    v_pk_fma_f32 v[252:253], v[60:61], v[14:15], v[252:253] op_sel_hi:[1,0,1]
    v_pk_fma_f32 v[206:207], v[46:47], v[14:15], v[206:207] op_sel_hi:[1,0,1]
    v_pk_fma_f32 v[254:255], v[62:63], v[14:15], v[254:255] op_sel_hi:[1,0,1]
    v_pk_mul_f32 v[192:193], v[192:193], v[18:19] op_sel_hi:[1,0]
    v_pk_mul_f32 v[194:195], v[194:195], v[18:19] op_sel_hi:[1,0]
    v_pk_mul_f32 v[196:197], v[196:197], v[18:19] op_sel_hi:[1,0]
    v_pk_mul_f32 v[198:199], v[198:199], v[18:19] op_sel_hi:[1,0]
    v_pk_mul_f32 v[200:201], v[200:201], v[18:19] op_sel_hi:[1,0]
    v_pk_mul_f32 v[202:203], v[202:203], v[18:19] op_sel_hi:[1,0]
    v_pk_mul_f32 v[204:205], v[204:205], v[18:19] op_sel_hi:[1,0]
    v_pk_mul_f32 v[206:207], v[206:207], v[18:19] op_sel_hi:[1,0]
    v_pk_mul_f32 v[192:193], v[192:193], v[240:241]
    v_pk_mul_f32 v[194:195], v[194:195], v[242:243]
    v_pk_mul_f32 v[196:197], v[196:197], v[244:245]
    v_pk_mul_f32 v[198:199], v[198:199], v[246:247]
    v_pk_mul_f32 v[200:201], v[200:201], v[248:249]
    v_pk_mul_f32 v[202:203], v[202:203], v[250:251]
    v_pk_mul_f32 v[204:205], v[204:205], v[252:253]
    v_pk_mul_f32 v[206:207], v[206:207], v[254:255]
    v_cvt_pk_bf16_f32 v240, v192, v193
    v_cvt_pk_bf16_f32 v241, v194, v195
    v_cvt_pk_bf16_f32 v242, v196, v197
    v_cvt_pk_bf16_f32 v243, v198, v199
    s_add_u32 s36, s33, 114688
    buffer_store_dwordx4 v[240:243], v20, s[16:19], s36 offen sc0 sc1
    v_cvt_pk_bf16_f32 v248, v200, v201
    v_cvt_pk_bf16_f32 v249, v202, v203
    v_cvt_pk_bf16_f32 v250, v204, v205
    v_cvt_pk_bf16_f32 v251, v206, v207
    s_add_u32 s36, s33, 115712
    buffer_store_dwordx4 v[248:251], v20, s[16:19], s36 offen sc0 sc1
    s_endpgm
L_parallel_sum__mha_block__glu_gated_bilinear__prompt_kernel_prod:
    s_cmp_ge_u32 s21, 12
    s_cbranch_scc1 L_parallel_sum__mha_block__glu_gated_bilinear__prompt_kernel_prod_glu
    s_setprio 3
    s_sub_u32 s23, s22, 4
    s_mul_i32 s24, s20, 327680
    s_add_u32 s8, s68, s24
    s_addc_u32 s9, s69, 0
    s_mov_b32 s10, 327680
    s_mov_b32 s11, 0x20000
    s_lshl_b32 s26, s23, 6
    v_lshrrev_b32 v2, 3, v1
    v_add_u32 v2, s26, v2
    v_mul_u32_u24 v2, 1280, v2
    v_and_b32 v3, 7, v1
    v_lshrrev_b32 v4, 4, v1
    v_xor_b32 v3, v3, v4
    v_lshlrev_b32 v3, 4, v3
    v_add_u32 v10, v2, v3
    v_xor_b32 v3, 64, v3
    v_add_u32 v14, v2, v3
    s_lshl_b32 s27, s23, 13
    v_add_u32 v11, 9216, v14
    v_add_u32 v12, 18432, v10
    v_add_u32 v13, 27648, v14
    v_add_u32 v15, 50176, v14
    v_add_u32 v16, 59392, v10
    v_add_u32 v17, 68608, v14
    v_add_u32 v14, 40960, v10
    s_add_u32 s41, s27, 3072
    s_mov_b32 s42, 0
    s_add_u32 m0, s41, 0
    s_nop 0
    buffer_load_dwordx4 v10, s[8:11], s42 offen offset:0 lds
    buffer_load_dwordx4 v11, s[8:11], s42 offen offset:1024 lds
    buffer_load_dwordx4 v12, s[8:11], s42 offen offset:2048 lds
    buffer_load_dwordx4 v13, s[8:11], s42 offen offset:3072 lds
    s_add_u32 m0, s41, 4096
    s_nop 0
    buffer_load_dwordx4 v14, s[8:11], s42 offen offset:0 lds
    buffer_load_dwordx4 v15, s[8:11], s42 offen offset:1024 lds
    buffer_load_dwordx4 v16, s[8:11], s42 offen offset:2048 lds
    buffer_load_dwordx4 v17, s[8:11], s42 offen offset:3072 lds
    s_mul_i32 s24, s21, 320
    s_add_u32 s12, s70, s24
    s_addc_u32 s13, s71, 0
    s_sub_u32 s14, 2457600, s24
    s_mov_b32 s15, 0x20000
    s_mov_b32 s25, s23
    s_mul_i32 s26, s25, 48
    s_add_u32 s26, s26, 0
    v_lshrrev_b32 v2, 2, v1
    v_add_u32 v2, s26, v2
    v_mul_u32_u24 v3, 205, v2
    v_lshrrev_b32 v3, 10, v3
    v_mul_u32_u24 v4, 5, v3
    v_sub_u32 v4, v2, v4
    v_lshlrev_b32 v4, 6, v4
    v_mul_u32_u24 v3, 3840, v3
    v_add_u32 v3, v3, v4
    v_and_b32 v4, 3, v1
    v_lshlrev_b32 v4, 4, v4
    v_add_u32 v3, v3, v4
    v_subrev_u32 v18, 0, v3
    v_mov_b32 v4, 0x7ff00000
    v_cmp_gt_u32 vcc, 160, v2
    s_nop 1
    v_cndmask_b32 v18, v4, v18, vcc
    s_mul_i32 s26, s25, 48
    s_add_u32 s26, s26, 16
    v_lshrrev_b32 v2, 2, v1
    v_add_u32 v2, s26, v2
    v_mul_u32_u24 v3, 205, v2
    v_lshrrev_b32 v3, 10, v3
    v_mul_u32_u24 v4, 5, v3
    v_sub_u32 v4, v2, v4
    v_lshlrev_b32 v4, 6, v4
    v_mul_u32_u24 v3, 3840, v3
    v_add_u32 v3, v3, v4
    v_and_b32 v4, 3, v1
    v_lshlrev_b32 v4, 4, v4
    v_add_u32 v3, v3, v4
    v_subrev_u32 v19, 1024, v3
    v_mov_b32 v4, 0x7ff00000
    v_cmp_gt_u32 vcc, 160, v2
    s_nop 1
    v_cndmask_b32 v19, v4, v19, vcc
    s_mul_i32 s26, s25, 48
    s_add_u32 s26, s26, 32
    v_lshrrev_b32 v2, 2, v1
    v_add_u32 v2, s26, v2
    v_mul_u32_u24 v3, 205, v2
    v_lshrrev_b32 v3, 10, v3
    v_mul_u32_u24 v4, 5, v3
    v_sub_u32 v4, v2, v4
    v_lshlrev_b32 v4, 6, v4
    v_mul_u32_u24 v3, 3840, v3
    v_add_u32 v3, v3, v4
    v_and_b32 v4, 3, v1
    v_lshlrev_b32 v4, 4, v4
    v_add_u32 v3, v3, v4
    v_subrev_u32 v20, 2048, v3
    v_mov_b32 v4, 0x7ff00000
    v_cmp_gt_u32 vcc, 160, v2
    s_nop 1
    v_cndmask_b32 v20, v4, v20, vcc
    s_mul_i32 s28, s23, 3072
    s_add_u32 s28, s28, 101376
    s_mov_b32 s40, 0
    s_mov_b32 m0, s28
    s_nop 0
    buffer_load_dwordx4 v18, s[12:15], s40 offen offset:0 lds
    buffer_load_dwordx4 v19, s[12:15], s40 offen offset:1024 lds
    buffer_load_dwordx4 v20, s[12:15], s40 offen offset:2048 lds
    s_add_u32 s44, s28, 12288
    s_mov_b32 s40, 122880
    s_mov_b32 m0, s44
    s_nop 0
    buffer_load_dwordx4 v18, s[12:15], s40 offen offset:0 lds
    buffer_load_dwordx4 v19, s[12:15], s40 offen offset:1024 lds
    buffer_load_dwordx4 v20, s[12:15], s40 offen offset:2048 lds
    s_add_u32 s41, s27, 35840
    s_mov_b32 s42, 128
    s_add_u32 m0, s41, 0
    s_nop 0
    buffer_load_dwordx4 v10, s[8:11], s42 offen offset:0 lds
    buffer_load_dwordx4 v11, s[8:11], s42 offen offset:1024 lds
    buffer_load_dwordx4 v12, s[8:11], s42 offen offset:2048 lds
    buffer_load_dwordx4 v13, s[8:11], s42 offen offset:3072 lds
    s_mul_i32 s26, s23, 80
    s_add_u32 s26, s26, 101376
    v_lshrrev_b32 v2, 1, v1
    v_mul_u32_u24 v2, 320, v2
    v_and_b32 v3, 1, v1
    v_lshlrev_b32 v3, 4, v3
    v_add3_u32 v21, v2, v3, s26
    v_mov_b32 v24, 0
    v_mov_b32 v25, 0
    v_mov_b32 v26, 0
    v_mov_b32 v27, 0
    v_mov_b32 v28, 0
    v_mov_b32 v29, 0
    v_mov_b32 v30, 0
    v_mov_b32 v31, 0
    v_mov_b32 v32, 0
    v_mov_b32 v33, 0
    v_mov_b32 v34, 0
    v_mov_b32 v35, 0
    v_mov_b32 v36, 0
    v_mov_b32 v37, 0
    v_mov_b32 v38, 0
    v_mov_b32 v39, 0
    v_mov_b32 v40, 0
    v_mov_b32 v41, 0
    v_mov_b32 v42, 0
    v_mov_b32 v43, 0
    v_mov_b32 v44, 0
    v_mov_b32 v45, 0
    v_mov_b32 v46, 0
    v_mov_b32 v47, 0
    s_waitcnt vmcnt(7)
    s_barrier
    s_add_u32 s41, s27, 35840
    s_mov_b32 s42, 128
    s_add_u32 m0, s41, 4096
    s_nop 0
    buffer_load_dwordx4 v14, s[8:11], s42 offen offset:0 lds
    buffer_load_dwordx4 v15, s[8:11], s42 offen offset:1024 lds
    buffer_load_dwordx4 v16, s[8:11], s42 offen offset:2048 lds
    buffer_load_dwordx4 v17, s[8:11], s42 offen offset:3072 lds
    s_add_u32 s44, s28, 24576
    s_mov_b32 s40, 245760
    s_mov_b32 m0, s44
    s_nop 0
    buffer_load_dwordx4 v18, s[12:15], s40 offen offset:0 lds
    buffer_load_dwordx4 v19, s[12:15], s40 offen offset:1024 lds
    buffer_load_dwordx4 v20, s[12:15], s40 offen offset:2048 lds
    s_mov_b32 s43, 0
    s_add_u32 s41, s27, 68608
    s_mov_b32 s42, 256
    s_add_u32 s44, s28, 36864
    s_mov_b32 s40, 368640
    s_add_u32 s46, s28, 61440
    s_add_u32 s47, s27, 101376
    s_mov_b32 s48, 0
    s_add_u32 s49, s27, 3072
    s_mov_b32 s52, s84
    s_mov_b32 s53, s85
    s_mov_b32 s54, 256
    s_mov_b32 s55, 0x20000
    s_lshl_b32 s50, s20, 3
    v_mov_b32 v66, 0
    s_lshl_b32 s58, s20, 8
    s_lshl_b32 s57, s23, 6
    s_add_u32 s58, s58, s57
    s_lshl_b32 s58, s58, 3
    s_add_u32 s58, s58, 23216128
    v_lshlrev_b32 v77, 3, v1
    s_mov_b32 s57, 0
    s_setprio 0
    s_branch L_parallel_sum__mha_block__glu_gated_bilinear__prompt_kernel_pqkv_ent
L_parallel_sum__mha_block__glu_gated_bilinear__prompt_kernel_pqkv_loop:
    s_waitcnt vmcnt(14)
    s_barrier
L_parallel_sum__mha_block__glu_gated_bilinear__prompt_kernel_pqkv_ent:
    s_cmp_lt_u32 s43, 6
    s_cbranch_scc1 L_parallel_sum__mha_block__glu_gated_bilinear__prompt_kernel_pqkv_sk
    s_cmp_eq_u32 s43, 6
    s_cbranch_scc1 L_parallel_sum__mha_block__glu_gated_bilinear__prompt_kernel_pqkv_lf
    v_and_b32 v64, v64, v65
    s_nop 0
    v_readfirstlane_b32 s56, v64
    s_cmp_eq_u32 s56, 1
    s_cbranch_scc0 L_parallel_sum__mha_block__glu_gated_bilinear__prompt_kernel_pqkv_sk
    s_mov_b32 s57, 1
    buffer_load_dwordx2 v[64:65], v77, s[16:19], s58 offen sc1
    s_branch L_parallel_sum__mha_block__glu_gated_bilinear__prompt_kernel_pqkv_sk
L_parallel_sum__mha_block__glu_gated_bilinear__prompt_kernel_pqkv_lf:
    buffer_load_dwordx2 v[64:65], v66, s[52:55], s50 offen sc1
L_parallel_sum__mha_block__glu_gated_bilinear__prompt_kernel_pqkv_sk:
    s_add_u32 m0, s41, 0
    s_nop 0
    buffer_load_dwordx4 v10, s[8:11], s42 offen offset:0 lds
    buffer_load_dwordx4 v11, s[8:11], s42 offen offset:1024 lds
    buffer_load_dwordx4 v12, s[8:11], s42 offen offset:2048 lds
    buffer_load_dwordx4 v13, s[8:11], s42 offen offset:3072 lds
    s_mov_b32 m0, s44
    s_nop 0
    buffer_load_dwordx4 v18, s[12:15], s40 offen offset:0 lds
    buffer_load_dwordx4 v19, s[12:15], s40 offen offset:1024 lds
    buffer_load_dwordx4 v20, s[12:15], s40 offen offset:2048 lds
    s_add_u32 s40, s40, 122880
    s_add_u32 s44, s44, 12288
    s_cmp_eq_u32 s44, s46
    s_cselect_b32 s44, s28, s44
    ds_read_b128 v[48:51], v21 offset:0
    ds_read_b128 v[52:55], v21 offset:32
    ds_read_b128 v[56:59], v21 offset:64
    s_add_u32 s48, s48, 1
    s_cmp_eq_u32 s48, 5
    s_mov_b32 s45, 12288
    s_cselect_b32 s45, 4294918144, s45
    s_cselect_b32 s48, 0, s48
    v_add_u32 v21, s45, v21
    s_waitcnt lgkmcnt(0)
    v_lshlrev_b32 v60, 16, v48
    v_and_b32 v61, 0xffff0000, v48
    v_add_f32 v24, v24, v60
    v_add_f32 v25, v25, v61
    v_lshlrev_b32 v62, 16, v49
    v_and_b32 v63, 0xffff0000, v49
    v_add_f32 v26, v26, v62
    v_add_f32 v27, v27, v63
    v_lshlrev_b32 v60, 16, v50
    v_and_b32 v61, 0xffff0000, v50
    v_add_f32 v28, v28, v60
    v_add_f32 v29, v29, v61
    v_lshlrev_b32 v62, 16, v51
    v_and_b32 v63, 0xffff0000, v51
    v_add_f32 v30, v30, v62
    v_add_f32 v31, v31, v63
    v_lshlrev_b32 v60, 16, v52
    v_and_b32 v61, 0xffff0000, v52
    v_add_f32 v32, v32, v60
    v_add_f32 v33, v33, v61
    v_lshlrev_b32 v62, 16, v53
    v_and_b32 v63, 0xffff0000, v53
    v_add_f32 v34, v34, v62
    v_add_f32 v35, v35, v63
    v_lshlrev_b32 v60, 16, v54
    v_and_b32 v61, 0xffff0000, v54
    v_add_f32 v36, v36, v60
    v_add_f32 v37, v37, v61
    v_lshlrev_b32 v62, 16, v55
    v_and_b32 v63, 0xffff0000, v55
    v_add_f32 v38, v38, v62
    v_add_f32 v39, v39, v63
    v_lshlrev_b32 v60, 16, v56
    v_and_b32 v61, 0xffff0000, v56
    v_add_f32 v40, v40, v60
    v_add_f32 v41, v41, v61
    v_lshlrev_b32 v62, 16, v57
    v_and_b32 v63, 0xffff0000, v57
    v_add_f32 v42, v42, v62
    v_add_f32 v43, v43, v63
    v_lshlrev_b32 v60, 16, v58
    v_and_b32 v61, 0xffff0000, v58
    v_add_f32 v44, v44, v60
    v_add_f32 v45, v45, v61
    v_lshlrev_b32 v62, 16, v59
    v_and_b32 v63, 0xffff0000, v59
    v_add_f32 v46, v46, v62
    v_add_f32 v47, v47, v63
    s_waitcnt vmcnt(18)
    s_cmp_eq_u32 s43, 0
    s_cbranch_scc1 L_parallel_sum__mha_block__glu_gated_bilinear__prompt_kernel_pqkv_f1
    s_waitcnt vmcnt(14)
L_parallel_sum__mha_block__glu_gated_bilinear__prompt_kernel_pqkv_f1:
    s_barrier
    s_add_u32 m0, s41, 4096
    s_nop 0
    buffer_load_dwordx4 v14, s[8:11], s42 offen offset:0 lds
    buffer_load_dwordx4 v15, s[8:11], s42 offen offset:1024 lds
    buffer_load_dwordx4 v16, s[8:11], s42 offen offset:2048 lds
    buffer_load_dwordx4 v17, s[8:11], s42 offen offset:3072 lds
    s_mov_b32 m0, s44
    s_nop 0
    buffer_load_dwordx4 v18, s[12:15], s40 offen offset:0 lds
    buffer_load_dwordx4 v19, s[12:15], s40 offen offset:1024 lds
    buffer_load_dwordx4 v20, s[12:15], s40 offen offset:2048 lds
    s_add_u32 s40, s40, 122880
    s_add_u32 s44, s44, 12288
    s_cmp_eq_u32 s44, s46
    s_cselect_b32 s44, s28, s44
    s_add_u32 s42, s42, 128
    s_add_u32 s41, s41, 32768
    s_cmp_eq_u32 s41, s47
    s_cselect_b32 s41, s49, s41
    ds_read_b128 v[48:51], v21 offset:0
    ds_read_b128 v[52:55], v21 offset:32
    ds_read_b128 v[56:59], v21 offset:64
    s_add_u32 s48, s48, 1
    s_cmp_eq_u32 s48, 5
    s_mov_b32 s45, 12288
    s_cselect_b32 s45, 4294918144, s45
    s_cselect_b32 s48, 0, s48
    v_add_u32 v21, s45, v21
    s_waitcnt lgkmcnt(0)
    v_lshlrev_b32 v60, 16, v48
    v_and_b32 v61, 0xffff0000, v48
    v_add_f32 v24, v24, v60
    v_add_f32 v25, v25, v61
    v_lshlrev_b32 v62, 16, v49
    v_and_b32 v63, 0xffff0000, v49
    v_add_f32 v26, v26, v62
    v_add_f32 v27, v27, v63
    v_lshlrev_b32 v60, 16, v50
    v_and_b32 v61, 0xffff0000, v50
    v_add_f32 v28, v28, v60
    v_add_f32 v29, v29, v61
    v_lshlrev_b32 v62, 16, v51
    v_and_b32 v63, 0xffff0000, v51
    v_add_f32 v30, v30, v62
    v_add_f32 v31, v31, v63
    v_lshlrev_b32 v60, 16, v52
    v_and_b32 v61, 0xffff0000, v52
    v_add_f32 v32, v32, v60
    v_add_f32 v33, v33, v61
    v_lshlrev_b32 v62, 16, v53
    v_and_b32 v63, 0xffff0000, v53
    v_add_f32 v34, v34, v62
    v_add_f32 v35, v35, v63
    v_lshlrev_b32 v60, 16, v54
    v_and_b32 v61, 0xffff0000, v54
    v_add_f32 v36, v36, v60
    v_add_f32 v37, v37, v61
    v_lshlrev_b32 v62, 16, v55
    v_and_b32 v63, 0xffff0000, v55
    v_add_f32 v38, v38, v62
    v_add_f32 v39, v39, v63
    v_lshlrev_b32 v60, 16, v56
    v_and_b32 v61, 0xffff0000, v56
    v_add_f32 v40, v40, v60
    v_add_f32 v41, v41, v61
    v_lshlrev_b32 v62, 16, v57
    v_and_b32 v63, 0xffff0000, v57
    v_add_f32 v42, v42, v62
    v_add_f32 v43, v43, v63
    v_lshlrev_b32 v60, 16, v58
    v_and_b32 v61, 0xffff0000, v58
    v_add_f32 v44, v44, v60
    v_add_f32 v45, v45, v61
    v_lshlrev_b32 v62, 16, v59
    v_and_b32 v63, 0xffff0000, v59
    v_add_f32 v46, v46, v62
    v_add_f32 v47, v47, v63
    s_add_u32 s43, s43, 1
    s_cmp_lt_u32 s43, 8
    s_cbranch_scc1 L_parallel_sum__mha_block__glu_gated_bilinear__prompt_kernel_pqkv_loop
    s_mov_b32 m0, s44
    s_nop 0
    buffer_load_dwordx4 v18, s[12:15], s40 offen offset:0 lds
    buffer_load_dwordx4 v19, s[12:15], s40 offen offset:1024 lds
    buffer_load_dwordx4 v20, s[12:15], s40 offen offset:2048 lds
    s_waitcnt vmcnt(17)
    s_barrier
    s_lshl_b32 s26, s23, 8
    v_lshlrev_b32 v78, 2, v1
    v_add_u32 v78, s26, v78
    s_cmp_eq_u32 s57, 1
    s_cbranch_scc0 L_parallel_sum__mha_block__glu_gated_bilinear__prompt_kernel_pqkv_ns16
    ds_write_b32 v78, v64 offset:0
    ds_write_b32 v78, v65 offset:1024
L_parallel_sum__mha_block__glu_gated_bilinear__prompt_kernel_pqkv_ns16:
    ds_read_b128 v[48:51], v21 offset:0
    ds_read_b128 v[52:55], v21 offset:32
    ds_read_b128 v[56:59], v21 offset:64
    s_add_u32 s48, s48, 1
    s_cmp_eq_u32 s48, 5
    s_mov_b32 s45, 12288
    s_cselect_b32 s45, 4294918144, s45
    s_cselect_b32 s48, 0, s48
    v_add_u32 v21, s45, v21
    s_waitcnt lgkmcnt(0)
    v_lshlrev_b32 v60, 16, v48
    v_and_b32 v61, 0xffff0000, v48
    v_add_f32 v24, v24, v60
    v_add_f32 v25, v25, v61
    v_lshlrev_b32 v62, 16, v49
    v_and_b32 v63, 0xffff0000, v49
    v_add_f32 v26, v26, v62
    v_add_f32 v27, v27, v63
    v_lshlrev_b32 v60, 16, v50
    v_and_b32 v61, 0xffff0000, v50
    v_add_f32 v28, v28, v60
    v_add_f32 v29, v29, v61
    v_lshlrev_b32 v62, 16, v51
    v_and_b32 v63, 0xffff0000, v51
    v_add_f32 v30, v30, v62
    v_add_f32 v31, v31, v63
    v_lshlrev_b32 v60, 16, v52
    v_and_b32 v61, 0xffff0000, v52
    v_add_f32 v32, v32, v60
    v_add_f32 v33, v33, v61
    v_lshlrev_b32 v62, 16, v53
    v_and_b32 v63, 0xffff0000, v53
    v_add_f32 v34, v34, v62
    v_add_f32 v35, v35, v63
    v_lshlrev_b32 v60, 16, v54
    v_and_b32 v61, 0xffff0000, v54
    v_add_f32 v36, v36, v60
    v_add_f32 v37, v37, v61
    v_lshlrev_b32 v62, 16, v55
    v_and_b32 v63, 0xffff0000, v55
    v_add_f32 v38, v38, v62
    v_add_f32 v39, v39, v63
    v_lshlrev_b32 v60, 16, v56
    v_and_b32 v61, 0xffff0000, v56
    v_add_f32 v40, v40, v60
    v_add_f32 v41, v41, v61
    v_lshlrev_b32 v62, 16, v57
    v_and_b32 v63, 0xffff0000, v57
    v_add_f32 v42, v42, v62
    v_add_f32 v43, v43, v63
    v_lshlrev_b32 v60, 16, v58
    v_and_b32 v61, 0xffff0000, v58
    v_add_f32 v44, v44, v60
    v_add_f32 v45, v45, v61
    v_lshlrev_b32 v62, 16, v59
    v_and_b32 v63, 0xffff0000, v59
    v_add_f32 v46, v46, v62
    v_add_f32 v47, v47, v63
    s_waitcnt vmcnt(3)
    s_barrier
    ds_read_b128 v[48:51], v21 offset:0
    ds_read_b128 v[52:55], v21 offset:32
    ds_read_b128 v[56:59], v21 offset:64
    s_add_u32 s48, s48, 1
    s_cmp_eq_u32 s48, 5
    s_mov_b32 s45, 12288
    s_cselect_b32 s45, 4294918144, s45
    s_cselect_b32 s48, 0, s48
    v_add_u32 v21, s45, v21
    s_waitcnt lgkmcnt(0)
    v_lshlrev_b32 v60, 16, v48
    v_and_b32 v61, 0xffff0000, v48
    v_add_f32 v24, v24, v60
    v_add_f32 v25, v25, v61
    v_lshlrev_b32 v62, 16, v49
    v_and_b32 v63, 0xffff0000, v49
    v_add_f32 v26, v26, v62
    v_add_f32 v27, v27, v63
    v_lshlrev_b32 v60, 16, v50
    v_and_b32 v61, 0xffff0000, v50
    v_add_f32 v28, v28, v60
    v_add_f32 v29, v29, v61
    v_lshlrev_b32 v62, 16, v51
    v_and_b32 v63, 0xffff0000, v51
    v_add_f32 v30, v30, v62
    v_add_f32 v31, v31, v63
    v_lshlrev_b32 v60, 16, v52
    v_and_b32 v61, 0xffff0000, v52
    v_add_f32 v32, v32, v60
    v_add_f32 v33, v33, v61
    v_lshlrev_b32 v62, 16, v53
    v_and_b32 v63, 0xffff0000, v53
    v_add_f32 v34, v34, v62
    v_add_f32 v35, v35, v63
    v_lshlrev_b32 v60, 16, v54
    v_and_b32 v61, 0xffff0000, v54
    v_add_f32 v36, v36, v60
    v_add_f32 v37, v37, v61
    v_lshlrev_b32 v62, 16, v55
    v_and_b32 v63, 0xffff0000, v55
    v_add_f32 v38, v38, v62
    v_add_f32 v39, v39, v63
    v_lshlrev_b32 v60, 16, v56
    v_and_b32 v61, 0xffff0000, v56
    v_add_f32 v40, v40, v60
    v_add_f32 v41, v41, v61
    v_lshlrev_b32 v62, 16, v57
    v_and_b32 v63, 0xffff0000, v57
    v_add_f32 v42, v42, v62
    v_add_f32 v43, v43, v63
    v_lshlrev_b32 v60, 16, v58
    v_and_b32 v61, 0xffff0000, v58
    v_add_f32 v44, v44, v60
    v_add_f32 v45, v45, v61
    v_lshlrev_b32 v62, 16, v59
    v_and_b32 v63, 0xffff0000, v59
    v_add_f32 v46, v46, v62
    v_add_f32 v47, v47, v63
    ds_read_b128 v[48:51], v21 offset:0
    ds_read_b128 v[52:55], v21 offset:32
    ds_read_b128 v[56:59], v21 offset:64
    s_add_u32 s48, s48, 1
    s_cmp_eq_u32 s48, 5
    s_mov_b32 s45, 12288
    s_cselect_b32 s45, 4294918144, s45
    s_cselect_b32 s48, 0, s48
    v_add_u32 v21, s45, v21
    s_waitcnt lgkmcnt(0)
    v_lshlrev_b32 v60, 16, v48
    v_and_b32 v61, 0xffff0000, v48
    v_add_f32 v24, v24, v60
    v_add_f32 v25, v25, v61
    v_lshlrev_b32 v62, 16, v49
    v_and_b32 v63, 0xffff0000, v49
    v_add_f32 v26, v26, v62
    v_add_f32 v27, v27, v63
    v_lshlrev_b32 v60, 16, v50
    v_and_b32 v61, 0xffff0000, v50
    v_add_f32 v28, v28, v60
    v_add_f32 v29, v29, v61
    v_lshlrev_b32 v62, 16, v51
    v_and_b32 v63, 0xffff0000, v51
    v_add_f32 v30, v30, v62
    v_add_f32 v31, v31, v63
    v_lshlrev_b32 v60, 16, v52
    v_and_b32 v61, 0xffff0000, v52
    v_add_f32 v32, v32, v60
    v_add_f32 v33, v33, v61
    v_lshlrev_b32 v62, 16, v53
    v_and_b32 v63, 0xffff0000, v53
    v_add_f32 v34, v34, v62
    v_add_f32 v35, v35, v63
    v_lshlrev_b32 v60, 16, v54
    v_and_b32 v61, 0xffff0000, v54
    v_add_f32 v36, v36, v60
    v_add_f32 v37, v37, v61
    v_lshlrev_b32 v62, 16, v55
    v_and_b32 v63, 0xffff0000, v55
    v_add_f32 v38, v38, v62
    v_add_f32 v39, v39, v63
    v_lshlrev_b32 v60, 16, v56
    v_and_b32 v61, 0xffff0000, v56
    v_add_f32 v40, v40, v60
    v_add_f32 v41, v41, v61
    v_lshlrev_b32 v62, 16, v57
    v_and_b32 v63, 0xffff0000, v57
    v_add_f32 v42, v42, v62
    v_add_f32 v43, v43, v63
    v_lshlrev_b32 v60, 16, v58
    v_and_b32 v61, 0xffff0000, v58
    v_add_f32 v44, v44, v60
    v_add_f32 v45, v45, v61
    v_lshlrev_b32 v62, 16, v59
    v_and_b32 v63, 0xffff0000, v59
    v_add_f32 v46, v46, v62
    v_add_f32 v47, v47, v63
    s_waitcnt vmcnt(0)
    s_cmp_eq_u32 s57, 1
    s_cbranch_scc1 L_parallel_sum__mha_block__glu_gated_bilinear__prompt_kernel_pqkv_st18
    s_mov_b32 s51, 200
L_parallel_sum__mha_block__glu_gated_bilinear__prompt_kernel_pqkv_poll:
    buffer_load_dwordx2 v[64:65], v66, s[52:55], s50 offen sc1
    s_waitcnt vmcnt(0)
    v_and_b32 v64, v64, v65
    s_nop 0
    v_readfirstlane_b32 s56, v64
    s_cmp_eq_u32 s56, 1
    s_cbranch_scc1 L_parallel_sum__mha_block__glu_gated_bilinear__prompt_kernel_pqkv_have
    s_sleep 8
    s_sub_u32 s51, s51, 1
    s_cmp_lg_u32 s51, 0
    s_cbranch_scc1 L_parallel_sum__mha_block__glu_gated_bilinear__prompt_kernel_pqkv_poll
    s_lshl_b32 s56, s23, 6
    v_add_u32 v67, s56, v1
    v_mul_u32_u24 v67, 1280, v67
    v_mov_b32 v72, 0
    v_mov_b32 v73, 0
    v_mov_b32 v74, 0
    v_mov_b32 v75, 0
    v_mov_b32 v76, 0x3f803f80
    s_mov_b32 s56, 0
L_parallel_sum__mha_block__glu_gated_bilinear__prompt_kernel_pqkv_fb:
    buffer_load_dwordx4 v[68:71], v67, s[8:11], s56 offen
    s_waitcnt vmcnt(0)
    v_dot2_f32_bf16 v72, v68, v76, v72
    v_dot2_f32_bf16 v74, v68, v68, v74
    v_dot2_f32_bf16 v73, v69, v76, v73
    v_dot2_f32_bf16 v75, v69, v69, v75
    v_dot2_f32_bf16 v72, v70, v76, v72
    v_dot2_f32_bf16 v74, v70, v70, v74
    v_dot2_f32_bf16 v73, v71, v76, v73
    v_dot2_f32_bf16 v75, v71, v71, v75
    s_add_u32 s56, s56, 16
    s_cmp_lt_u32 s56, 1280
    s_cbranch_scc1 L_parallel_sum__mha_block__glu_gated_bilinear__prompt_kernel_pqkv_fb
    s_nop 3
    v_add_f32 v72, v72, v73
    v_add_f32 v74, v74, v75
    v_mul_f32 v64, 986500301, v72
    v_mul_f32 v74, 986500301, v74
    v_fma_f32 v74, -v64, v64, v74
    v_max_f32 v74, 0, v74
    v_add_f32 v74, 925353388, v74
    v_rsq_f32 v65, v74
    s_branch L_parallel_sum__mha_block__glu_gated_bilinear__prompt_kernel_pqkv_wst
L_parallel_sum__mha_block__glu_gated_bilinear__prompt_kernel_pqkv_have:
    buffer_load_dwordx2 v[64:65], v77, s[16:19], s58 offen sc1
    s_waitcnt vmcnt(0)
L_parallel_sum__mha_block__glu_gated_bilinear__prompt_kernel_pqkv_wst:
    ds_write_b32 v78, v64 offset:0
    ds_write_b32 v78, v65 offset:1024
L_parallel_sum__mha_block__glu_gated_bilinear__prompt_kernel_pqkv_st18:
    s_waitcnt lgkmcnt(0)
    s_barrier
    ds_read_b128 v[48:51], v21 offset:0
    ds_read_b128 v[52:55], v21 offset:32
    ds_read_b128 v[56:59], v21 offset:64
    s_add_u32 s48, s48, 1
    s_cmp_eq_u32 s48, 5
    s_mov_b32 s45, 12288
    s_cselect_b32 s45, 4294918144, s45
    s_cselect_b32 s48, 0, s48
    v_add_u32 v21, s45, v21
    s_waitcnt lgkmcnt(0)
    v_lshlrev_b32 v60, 16, v48
    v_and_b32 v61, 0xffff0000, v48
    v_add_f32 v24, v24, v60
    v_add_f32 v25, v25, v61
    v_lshlrev_b32 v62, 16, v49
    v_and_b32 v63, 0xffff0000, v49
    v_add_f32 v26, v26, v62
    v_add_f32 v27, v27, v63
    v_lshlrev_b32 v60, 16, v50
    v_and_b32 v61, 0xffff0000, v50
    v_add_f32 v28, v28, v60
    v_add_f32 v29, v29, v61
    v_lshlrev_b32 v62, 16, v51
    v_and_b32 v63, 0xffff0000, v51
    v_add_f32 v30, v30, v62
    v_add_f32 v31, v31, v63
    v_lshlrev_b32 v60, 16, v52
    v_and_b32 v61, 0xffff0000, v52
    v_add_f32 v32, v32, v60
    v_add_f32 v33, v33, v61
    v_lshlrev_b32 v62, 16, v53
    v_and_b32 v63, 0xffff0000, v53
    v_add_f32 v34, v34, v62
    v_add_f32 v35, v35, v63
    v_lshlrev_b32 v60, 16, v54
    v_and_b32 v61, 0xffff0000, v54
    v_add_f32 v36, v36, v60
    v_add_f32 v37, v37, v61
    v_lshlrev_b32 v62, 16, v55
    v_and_b32 v63, 0xffff0000, v55
    v_add_f32 v38, v38, v62
    v_add_f32 v39, v39, v63
    v_lshlrev_b32 v60, 16, v56
    v_and_b32 v61, 0xffff0000, v56
    v_add_f32 v40, v40, v60
    v_add_f32 v41, v41, v61
    v_lshlrev_b32 v62, 16, v57
    v_and_b32 v63, 0xffff0000, v57
    v_add_f32 v42, v42, v62
    v_add_f32 v43, v43, v63
    v_lshlrev_b32 v60, 16, v58
    v_and_b32 v61, 0xffff0000, v58
    v_add_f32 v44, v44, v60
    v_add_f32 v45, v45, v61
    v_lshlrev_b32 v62, 16, v59
    v_and_b32 v63, 0xffff0000, v59
    v_add_f32 v46, v46, v62
    v_add_f32 v47, v47, v63
    s_waitcnt vmcnt(0)
    s_add_u32 s26, s27, 35840
    v_mul_u32_u24 v2, 96, v1
    v_add_u32 v2, s26, v2
    ds_write_b128 v2, v[24:27] offset:0
    ds_write_b128 v2, v[28:31] offset:16
    ds_write_b128 v2, v[32:35] offset:32
    ds_write_b128 v2, v[36:39] offset:48
    ds_write_b128 v2, v[40:43] offset:64
    ds_write_b128 v2, v[44:47] offset:80
    v_lshrrev_b32 v3, 4, v1
    v_lshlrev_b32 v3, 5, v3
    v_bfe_u32 v4, v1, 3, 1
    v_mul_u32_u24 v4, 96, v4
    v_and_b32 v5, 7, v1
    v_lshlrev_b32 v5, 2, v5
    v_add3_u32 v3, v3, v4, v5
    v_min_u32 v3, 188, v3
    v_add_u32 v3, s26, v3
    s_waitcnt lgkmcnt(0)
    ds_read_b32 v24, v3 offset:0
    ds_read_b32 v25, v3 offset:192
    ds_read_b32 v26, v3 offset:384
    ds_read_b32 v27, v3 offset:576
    ds_read_b32 v28, v3 offset:768
    ds_read_b32 v29, v3 offset:960
    ds_read_b32 v30, v3 offset:1152
    ds_read_b32 v31, v3 offset:1344
    ds_read_b32 v32, v3 offset:1536
    ds_read_b32 v33, v3 offset:1728
    ds_read_b32 v34, v3 offset:1920
    ds_read_b32 v35, v3 offset:2112
    ds_read_b32 v36, v3 offset:2304
    ds_read_b32 v37, v3 offset:2496
    ds_read_b32 v38, v3 offset:2688
    ds_read_b32 v39, v3 offset:2880
    ds_read_b32 v48, v3 offset:3072
    ds_read_b32 v49, v3 offset:3264
    ds_read_b32 v50, v3 offset:3456
    ds_read_b32 v51, v3 offset:3648
    ds_read_b32 v52, v3 offset:3840
    ds_read_b32 v53, v3 offset:4032
    ds_read_b32 v54, v3 offset:4224
    ds_read_b32 v55, v3 offset:4416
    ds_read_b32 v56, v3 offset:4608
    ds_read_b32 v57, v3 offset:4800
    ds_read_b32 v58, v3 offset:4992
    ds_read_b32 v59, v3 offset:5184
    ds_read_b32 v60, v3 offset:5376
    ds_read_b32 v61, v3 offset:5568
    ds_read_b32 v62, v3 offset:5760
    ds_read_b32 v63, v3 offset:5952
    s_barrier
    s_waitcnt lgkmcnt(0)
    v_add_f32 v24, v24, v48
    v_add_f32 v25, v25, v49
    v_add_f32 v26, v26, v50
    v_add_f32 v27, v27, v51
    v_add_f32 v28, v28, v52
    v_add_f32 v29, v29, v53
    v_add_f32 v30, v30, v54
    v_add_f32 v31, v31, v55
    v_add_f32 v32, v32, v56
    v_add_f32 v33, v33, v57
    v_add_f32 v34, v34, v58
    v_add_f32 v35, v35, v59
    v_add_f32 v36, v36, v60
    v_add_f32 v37, v37, v61
    v_add_f32 v38, v38, v62
    v_add_f32 v39, v39, v63
    v_add_f32 v24, v24, v32
    v_add_f32 v25, v25, v33
    v_add_f32 v26, v26, v34
    v_add_f32 v27, v27, v35
    v_add_f32 v28, v28, v36
    v_add_f32 v29, v29, v37
    v_add_f32 v30, v30, v38
    v_add_f32 v31, v31, v39
    v_add_f32 v24, v24, v28
    v_add_f32 v25, v25, v29
    v_add_f32 v26, v26, v30
    v_add_f32 v27, v27, v31
    v_add_f32 v24, v24, v26
    v_add_f32 v25, v25, v27
    v_add_f32 v24, v24, v25
    s_mul_i32 s26, s23, 160
    v_lshlrev_b32 v2, 2, v1
    v_add_u32 v2, s26, v2
    v_cmp_gt_u32 vcc, 40, v1
    s_and_saveexec_b64 s[30:31], vcc
    ds_write_b32 v2, v24 offset:2048
    s_mov_b64 exec, s[30:31]
    s_waitcnt lgkmcnt(0)
    s_barrier
    s_endpgm
L_parallel_sum__mha_block__glu_gated_bilinear__prompt_kernel_prod_glu:
    s_setprio 3
    s_sub_u32 s23, s22, 4
    s_mul_i32 s24, s20, 327680
    s_add_u32 s8, s68, s24
    s_addc_u32 s9, s69, 0
    s_mov_b32 s10, 327680
    s_mov_b32 s11, 0x20000
    s_lshl_b32 s26, s23, 6
    v_lshrrev_b32 v2, 3, v1
    v_add_u32 v2, s26, v2
    v_mul_u32_u24 v2, 1280, v2
    v_and_b32 v3, 7, v1
    v_lshrrev_b32 v4, 4, v1
    v_xor_b32 v3, v3, v4
    v_lshlrev_b32 v3, 4, v3
    v_add_u32 v10, v2, v3
    v_xor_b32 v3, 64, v3
    v_add_u32 v14, v2, v3
    s_lshl_b32 s27, s23, 13
    v_add_u32 v11, 9216, v14
    v_add_u32 v12, 18432, v10
    v_add_u32 v13, 27648, v14
    v_add_u32 v15, 50176, v14
    v_add_u32 v16, 59392, v10
    v_add_u32 v17, 68608, v14
    v_add_u32 v14, 40960, v10
    s_add_u32 s41, s27, 3072
    s_mov_b32 s42, 0
    s_add_u32 m0, s41, 0
    s_nop 0
    buffer_load_dwordx4 v10, s[8:11], s42 offen offset:0 lds
    buffer_load_dwordx4 v11, s[8:11], s42 offen offset:1024 lds
    buffer_load_dwordx4 v12, s[8:11], s42 offen offset:2048 lds
    buffer_load_dwordx4 v13, s[8:11], s42 offen offset:3072 lds
    s_add_u32 m0, s41, 4096
    s_nop 0
    buffer_load_dwordx4 v14, s[8:11], s42 offen offset:0 lds
    buffer_load_dwordx4 v15, s[8:11], s42 offen offset:1024 lds
    buffer_load_dwordx4 v16, s[8:11], s42 offen offset:2048 lds
    buffer_load_dwordx4 v17, s[8:11], s42 offen offset:3072 lds
    s_sub_u32 s24, s21, 12
    s_mul_i32 s24, s24, 192
    s_cmp_lt_u32 s23, 2
    s_cselect_b32 s12, s76, s78
    s_cselect_b32 s13, s77, s79
    s_add_u32 s12, s12, s24
    s_addc_u32 s13, s13, 0
    s_sub_u32 s14, 2211840, s24
    s_mov_b32 s15, 0x20000
    s_and_b32 s25, s23, 1
    s_mul_i32 s26, s25, 48
    s_add_u32 s26, s26, 0
    v_lshrrev_b32 v2, 2, v1
    v_add_u32 v2, s26, v2
    v_mul_u32_u24 v3, 171, v2
    v_lshrrev_b32 v3, 9, v3
    v_mul_u32_u24 v4, 3, v3
    v_sub_u32 v4, v2, v4
    v_lshlrev_b32 v4, 6, v4
    v_mul_u32_u24 v3, 3456, v3
    v_add_u32 v3, v3, v4
    v_and_b32 v4, 3, v1
    v_lshlrev_b32 v4, 4, v4
    v_add_u32 v3, v3, v4
    v_subrev_u32 v18, 0, v3
    s_mul_i32 s26, s25, 48
    s_add_u32 s26, s26, 16
    v_lshrrev_b32 v2, 2, v1
    v_add_u32 v2, s26, v2
    v_mul_u32_u24 v3, 171, v2
    v_lshrrev_b32 v3, 9, v3
    v_mul_u32_u24 v4, 3, v3
    v_sub_u32 v4, v2, v4
    v_lshlrev_b32 v4, 6, v4
    v_mul_u32_u24 v3, 3456, v3
    v_add_u32 v3, v3, v4
    v_and_b32 v4, 3, v1
    v_lshlrev_b32 v4, 4, v4
    v_add_u32 v3, v3, v4
    v_subrev_u32 v19, 1024, v3
    s_mul_i32 s26, s25, 48
    s_add_u32 s26, s26, 32
    v_lshrrev_b32 v2, 2, v1
    v_add_u32 v2, s26, v2
    v_mul_u32_u24 v3, 171, v2
    v_lshrrev_b32 v3, 9, v3
    v_mul_u32_u24 v4, 3, v3
    v_sub_u32 v4, v2, v4
    v_lshlrev_b32 v4, 6, v4
    v_mul_u32_u24 v3, 3456, v3
    v_add_u32 v3, v3, v4
    v_and_b32 v4, 3, v1
    v_lshlrev_b32 v4, 4, v4
    v_add_u32 v3, v3, v4
    v_subrev_u32 v20, 2048, v3
    s_mul_i32 s28, s23, 3072
    s_add_u32 s28, s28, 101376
    s_mov_b32 s40, 0
    s_mov_b32 m0, s28
    s_nop 0
    buffer_load_dwordx4 v18, s[12:15], s40 offen offset:0 lds
    buffer_load_dwordx4 v19, s[12:15], s40 offen offset:1024 lds
    buffer_load_dwordx4 v20, s[12:15], s40 offen offset:2048 lds
    s_add_u32 s44, s28, 12288
    s_mov_b32 s40, 110592
    s_mov_b32 m0, s44
    s_nop 0
    buffer_load_dwordx4 v18, s[12:15], s40 offen offset:0 lds
    buffer_load_dwordx4 v19, s[12:15], s40 offen offset:1024 lds
    buffer_load_dwordx4 v20, s[12:15], s40 offen offset:2048 lds
    s_add_u32 s41, s27, 35840
    s_mov_b32 s42, 128
    s_add_u32 m0, s41, 0
    s_nop 0
    buffer_load_dwordx4 v10, s[8:11], s42 offen offset:0 lds
    buffer_load_dwordx4 v11, s[8:11], s42 offen offset:1024 lds
    buffer_load_dwordx4 v12, s[8:11], s42 offen offset:2048 lds
    buffer_load_dwordx4 v13, s[8:11], s42 offen offset:3072 lds
    s_lshr_b32 s26, s23, 1
    s_mul_i32 s26, s26, 6144
    s_and_b32 s30, s23, 1
    s_mul_i32 s30, s30, 96
    s_add_u32 s26, s26, s30
    s_add_u32 s26, s26, 101376
    v_lshrrev_b32 v2, 1, v1
    v_mul_u32_u24 v2, 192, v2
    v_and_b32 v3, 1, v1
    v_lshlrev_b32 v3, 4, v3
    v_add3_u32 v21, v2, v3, s26
    v_mov_b32 v24, 0
    v_mov_b32 v25, 0
    v_mov_b32 v26, 0
    v_mov_b32 v27, 0
    v_mov_b32 v28, 0
    v_mov_b32 v29, 0
    v_mov_b32 v30, 0
    v_mov_b32 v31, 0
    v_mov_b32 v32, 0
    v_mov_b32 v33, 0
    v_mov_b32 v34, 0
    v_mov_b32 v35, 0
    v_mov_b32 v36, 0
    v_mov_b32 v37, 0
    v_mov_b32 v38, 0
    v_mov_b32 v39, 0
    v_mov_b32 v40, 0
    v_mov_b32 v41, 0
    v_mov_b32 v42, 0
    v_mov_b32 v43, 0
    v_mov_b32 v44, 0
    v_mov_b32 v45, 0
    v_mov_b32 v46, 0
    v_mov_b32 v47, 0
    s_waitcnt vmcnt(7)
    s_barrier
    s_add_u32 s41, s27, 35840
    s_mov_b32 s42, 128
    s_add_u32 m0, s41, 4096
    s_nop 0
    buffer_load_dwordx4 v14, s[8:11], s42 offen offset:0 lds
    buffer_load_dwordx4 v15, s[8:11], s42 offen offset:1024 lds
    buffer_load_dwordx4 v16, s[8:11], s42 offen offset:2048 lds
    buffer_load_dwordx4 v17, s[8:11], s42 offen offset:3072 lds
    s_add_u32 s44, s28, 24576
    s_mov_b32 s40, 221184
    s_mov_b32 m0, s44
    s_nop 0
    buffer_load_dwordx4 v18, s[12:15], s40 offen offset:0 lds
    buffer_load_dwordx4 v19, s[12:15], s40 offen offset:1024 lds
    buffer_load_dwordx4 v20, s[12:15], s40 offen offset:2048 lds
    s_mov_b32 s43, 0
    s_add_u32 s41, s27, 68608
    s_mov_b32 s42, 256
    s_add_u32 s44, s28, 36864
    s_mov_b32 s40, 331776
    s_add_u32 s46, s28, 61440
    s_add_u32 s47, s27, 101376
    s_mov_b32 s48, 0
    s_add_u32 s49, s27, 3072
    s_mov_b32 s52, s84
    s_mov_b32 s53, s85
    s_mov_b32 s54, 256
    s_mov_b32 s55, 0x20000
    s_lshl_b32 s50, s20, 3
    v_mov_b32 v66, 0
    s_lshl_b32 s58, s20, 8
    s_lshl_b32 s57, s23, 6
    s_add_u32 s58, s58, s57
    s_lshl_b32 s58, s58, 3
    s_add_u32 s58, s58, 23216128
    v_lshlrev_b32 v77, 3, v1
    s_mov_b32 s57, 0
    s_setprio 0
    s_branch L_parallel_sum__mha_block__glu_gated_bilinear__prompt_kernel_pglu_ent
L_parallel_sum__mha_block__glu_gated_bilinear__prompt_kernel_pglu_loop:
    s_waitcnt vmcnt(14)
    s_barrier
L_parallel_sum__mha_block__glu_gated_bilinear__prompt_kernel_pglu_ent:
    s_cmp_lt_u32 s43, 6
    s_cbranch_scc1 L_parallel_sum__mha_block__glu_gated_bilinear__prompt_kernel_pglu_sk
    s_cmp_eq_u32 s43, 6
    s_cbranch_scc1 L_parallel_sum__mha_block__glu_gated_bilinear__prompt_kernel_pglu_lf
    v_and_b32 v64, v64, v65
    s_nop 0
    v_readfirstlane_b32 s56, v64
    s_cmp_eq_u32 s56, 1
    s_cbranch_scc0 L_parallel_sum__mha_block__glu_gated_bilinear__prompt_kernel_pglu_sk
    s_mov_b32 s57, 1
    buffer_load_dwordx2 v[64:65], v77, s[16:19], s58 offen sc1
    s_branch L_parallel_sum__mha_block__glu_gated_bilinear__prompt_kernel_pglu_sk
L_parallel_sum__mha_block__glu_gated_bilinear__prompt_kernel_pglu_lf:
    buffer_load_dwordx2 v[64:65], v66, s[52:55], s50 offen sc1
L_parallel_sum__mha_block__glu_gated_bilinear__prompt_kernel_pglu_sk:
    s_add_u32 m0, s41, 0
    s_nop 0
    buffer_load_dwordx4 v10, s[8:11], s42 offen offset:0 lds
    buffer_load_dwordx4 v11, s[8:11], s42 offen offset:1024 lds
    buffer_load_dwordx4 v12, s[8:11], s42 offen offset:2048 lds
    buffer_load_dwordx4 v13, s[8:11], s42 offen offset:3072 lds
    s_mov_b32 m0, s44
    s_nop 0
    buffer_load_dwordx4 v18, s[12:15], s40 offen offset:0 lds
    buffer_load_dwordx4 v19, s[12:15], s40 offen offset:1024 lds
    buffer_load_dwordx4 v20, s[12:15], s40 offen offset:2048 lds
    s_add_u32 s40, s40, 110592
    s_add_u32 s44, s44, 12288
    s_cmp_eq_u32 s44, s46
    s_cselect_b32 s44, s28, s44
    ds_read_b128 v[48:51], v21 offset:0
    ds_read_b128 v[52:55], v21 offset:32
    ds_read_b128 v[56:59], v21 offset:64
    s_add_u32 s48, s48, 1
    s_cmp_eq_u32 s48, 5
    s_mov_b32 s45, 12288
    s_cselect_b32 s45, 4294918144, s45
    s_cselect_b32 s48, 0, s48
    v_add_u32 v21, s45, v21
    s_waitcnt lgkmcnt(0)
    v_lshlrev_b32 v60, 16, v48
    v_and_b32 v61, 0xffff0000, v48
    v_add_f32 v24, v24, v60
    v_add_f32 v25, v25, v61
    v_lshlrev_b32 v62, 16, v49
    v_and_b32 v63, 0xffff0000, v49
    v_add_f32 v26, v26, v62
    v_add_f32 v27, v27, v63
    v_lshlrev_b32 v60, 16, v50
    v_and_b32 v61, 0xffff0000, v50
    v_add_f32 v28, v28, v60
    v_add_f32 v29, v29, v61
    v_lshlrev_b32 v62, 16, v51
    v_and_b32 v63, 0xffff0000, v51
    v_add_f32 v30, v30, v62
    v_add_f32 v31, v31, v63
    v_lshlrev_b32 v60, 16, v52
    v_and_b32 v61, 0xffff0000, v52
    v_add_f32 v32, v32, v60
    v_add_f32 v33, v33, v61
    v_lshlrev_b32 v62, 16, v53
    v_and_b32 v63, 0xffff0000, v53
    v_add_f32 v34, v34, v62
    v_add_f32 v35, v35, v63
    v_lshlrev_b32 v60, 16, v54
    v_and_b32 v61, 0xffff0000, v54
    v_add_f32 v36, v36, v60
    v_add_f32 v37, v37, v61
    v_lshlrev_b32 v62, 16, v55
    v_and_b32 v63, 0xffff0000, v55
    v_add_f32 v38, v38, v62
    v_add_f32 v39, v39, v63
    v_lshlrev_b32 v60, 16, v56
    v_and_b32 v61, 0xffff0000, v56
    v_add_f32 v40, v40, v60
    v_add_f32 v41, v41, v61
    v_lshlrev_b32 v62, 16, v57
    v_and_b32 v63, 0xffff0000, v57
    v_add_f32 v42, v42, v62
    v_add_f32 v43, v43, v63
    v_lshlrev_b32 v60, 16, v58
    v_and_b32 v61, 0xffff0000, v58
    v_add_f32 v44, v44, v60
    v_add_f32 v45, v45, v61
    v_lshlrev_b32 v62, 16, v59
    v_and_b32 v63, 0xffff0000, v59
    v_add_f32 v46, v46, v62
    v_add_f32 v47, v47, v63
    s_waitcnt vmcnt(18)
    s_cmp_eq_u32 s43, 0
    s_cbranch_scc1 L_parallel_sum__mha_block__glu_gated_bilinear__prompt_kernel_pglu_f1
    s_waitcnt vmcnt(14)
L_parallel_sum__mha_block__glu_gated_bilinear__prompt_kernel_pglu_f1:
    s_barrier
    s_add_u32 m0, s41, 4096
    s_nop 0
    buffer_load_dwordx4 v14, s[8:11], s42 offen offset:0 lds
    buffer_load_dwordx4 v15, s[8:11], s42 offen offset:1024 lds
    buffer_load_dwordx4 v16, s[8:11], s42 offen offset:2048 lds
    buffer_load_dwordx4 v17, s[8:11], s42 offen offset:3072 lds
    s_mov_b32 m0, s44
    s_nop 0
    buffer_load_dwordx4 v18, s[12:15], s40 offen offset:0 lds
    buffer_load_dwordx4 v19, s[12:15], s40 offen offset:1024 lds
    buffer_load_dwordx4 v20, s[12:15], s40 offen offset:2048 lds
    s_add_u32 s40, s40, 110592
    s_add_u32 s44, s44, 12288
    s_cmp_eq_u32 s44, s46
    s_cselect_b32 s44, s28, s44
    s_add_u32 s42, s42, 128
    s_add_u32 s41, s41, 32768
    s_cmp_eq_u32 s41, s47
    s_cselect_b32 s41, s49, s41
    ds_read_b128 v[48:51], v21 offset:0
    ds_read_b128 v[52:55], v21 offset:32
    ds_read_b128 v[56:59], v21 offset:64
    s_add_u32 s48, s48, 1
    s_cmp_eq_u32 s48, 5
    s_mov_b32 s45, 12288
    s_cselect_b32 s45, 4294918144, s45
    s_cselect_b32 s48, 0, s48
    v_add_u32 v21, s45, v21
    s_waitcnt lgkmcnt(0)
    v_lshlrev_b32 v60, 16, v48
    v_and_b32 v61, 0xffff0000, v48
    v_add_f32 v24, v24, v60
    v_add_f32 v25, v25, v61
    v_lshlrev_b32 v62, 16, v49
    v_and_b32 v63, 0xffff0000, v49
    v_add_f32 v26, v26, v62
    v_add_f32 v27, v27, v63
    v_lshlrev_b32 v60, 16, v50
    v_and_b32 v61, 0xffff0000, v50
    v_add_f32 v28, v28, v60
    v_add_f32 v29, v29, v61
    v_lshlrev_b32 v62, 16, v51
    v_and_b32 v63, 0xffff0000, v51
    v_add_f32 v30, v30, v62
    v_add_f32 v31, v31, v63
    v_lshlrev_b32 v60, 16, v52
    v_and_b32 v61, 0xffff0000, v52
    v_add_f32 v32, v32, v60
    v_add_f32 v33, v33, v61
    v_lshlrev_b32 v62, 16, v53
    v_and_b32 v63, 0xffff0000, v53
    v_add_f32 v34, v34, v62
    v_add_f32 v35, v35, v63
    v_lshlrev_b32 v60, 16, v54
    v_and_b32 v61, 0xffff0000, v54
    v_add_f32 v36, v36, v60
    v_add_f32 v37, v37, v61
    v_lshlrev_b32 v62, 16, v55
    v_and_b32 v63, 0xffff0000, v55
    v_add_f32 v38, v38, v62
    v_add_f32 v39, v39, v63
    v_lshlrev_b32 v60, 16, v56
    v_and_b32 v61, 0xffff0000, v56
    v_add_f32 v40, v40, v60
    v_add_f32 v41, v41, v61
    v_lshlrev_b32 v62, 16, v57
    v_and_b32 v63, 0xffff0000, v57
    v_add_f32 v42, v42, v62
    v_add_f32 v43, v43, v63
    v_lshlrev_b32 v60, 16, v58
    v_and_b32 v61, 0xffff0000, v58
    v_add_f32 v44, v44, v60
    v_add_f32 v45, v45, v61
    v_lshlrev_b32 v62, 16, v59
    v_and_b32 v63, 0xffff0000, v59
    v_add_f32 v46, v46, v62
    v_add_f32 v47, v47, v63
    s_add_u32 s43, s43, 1
    s_cmp_lt_u32 s43, 8
    s_cbranch_scc1 L_parallel_sum__mha_block__glu_gated_bilinear__prompt_kernel_pglu_loop
    s_mov_b32 m0, s44
    s_nop 0
    buffer_load_dwordx4 v18, s[12:15], s40 offen offset:0 lds
    buffer_load_dwordx4 v19, s[12:15], s40 offen offset:1024 lds
    buffer_load_dwordx4 v20, s[12:15], s40 offen offset:2048 lds
    s_waitcnt vmcnt(17)
    s_barrier
    s_lshl_b32 s26, s23, 8
    v_lshlrev_b32 v78, 2, v1
    v_add_u32 v78, s26, v78
    s_cmp_eq_u32 s57, 1
    s_cbranch_scc0 L_parallel_sum__mha_block__glu_gated_bilinear__prompt_kernel_pglu_ns16
    ds_write_b32 v78, v64 offset:0
    ds_write_b32 v78, v65 offset:1024
L_parallel_sum__mha_block__glu_gated_bilinear__prompt_kernel_pglu_ns16:
    ds_read_b128 v[48:51], v21 offset:0
    ds_read_b128 v[52:55], v21 offset:32
    ds_read_b128 v[56:59], v21 offset:64
    s_add_u32 s48, s48, 1
    s_cmp_eq_u32 s48, 5
    s_mov_b32 s45, 12288
    s_cselect_b32 s45, 4294918144, s45
    s_cselect_b32 s48, 0, s48
    v_add_u32 v21, s45, v21
    s_waitcnt lgkmcnt(0)
    v_lshlrev_b32 v60, 16, v48
    v_and_b32 v61, 0xffff0000, v48
    v_add_f32 v24, v24, v60
    v_add_f32 v25, v25, v61
    v_lshlrev_b32 v62, 16, v49
    v_and_b32 v63, 0xffff0000, v49
    v_add_f32 v26, v26, v62
    v_add_f32 v27, v27, v63
    v_lshlrev_b32 v60, 16, v50
    v_and_b32 v61, 0xffff0000, v50
    v_add_f32 v28, v28, v60
    v_add_f32 v29, v29, v61
    v_lshlrev_b32 v62, 16, v51
    v_and_b32 v63, 0xffff0000, v51
    v_add_f32 v30, v30, v62
    v_add_f32 v31, v31, v63
    v_lshlrev_b32 v60, 16, v52
    v_and_b32 v61, 0xffff0000, v52
    v_add_f32 v32, v32, v60
    v_add_f32 v33, v33, v61
    v_lshlrev_b32 v62, 16, v53
    v_and_b32 v63, 0xffff0000, v53
    v_add_f32 v34, v34, v62
    v_add_f32 v35, v35, v63
    v_lshlrev_b32 v60, 16, v54
    v_and_b32 v61, 0xffff0000, v54
    v_add_f32 v36, v36, v60
    v_add_f32 v37, v37, v61
    v_lshlrev_b32 v62, 16, v55
    v_and_b32 v63, 0xffff0000, v55
    v_add_f32 v38, v38, v62
    v_add_f32 v39, v39, v63
    v_lshlrev_b32 v60, 16, v56
    v_and_b32 v61, 0xffff0000, v56
    v_add_f32 v40, v40, v60
    v_add_f32 v41, v41, v61
    v_lshlrev_b32 v62, 16, v57
    v_and_b32 v63, 0xffff0000, v57
    v_add_f32 v42, v42, v62
    v_add_f32 v43, v43, v63
    v_lshlrev_b32 v60, 16, v58
    v_and_b32 v61, 0xffff0000, v58
    v_add_f32 v44, v44, v60
    v_add_f32 v45, v45, v61
    v_lshlrev_b32 v62, 16, v59
    v_and_b32 v63, 0xffff0000, v59
    v_add_f32 v46, v46, v62
    v_add_f32 v47, v47, v63
    s_waitcnt vmcnt(3)
    s_barrier
    ds_read_b128 v[48:51], v21 offset:0
    ds_read_b128 v[52:55], v21 offset:32
    ds_read_b128 v[56:59], v21 offset:64
    s_add_u32 s48, s48, 1
    s_cmp_eq_u32 s48, 5
    s_mov_b32 s45, 12288
    s_cselect_b32 s45, 4294918144, s45
    s_cselect_b32 s48, 0, s48
    v_add_u32 v21, s45, v21
    s_waitcnt lgkmcnt(0)
    v_lshlrev_b32 v60, 16, v48
    v_and_b32 v61, 0xffff0000, v48
    v_add_f32 v24, v24, v60
    v_add_f32 v25, v25, v61
    v_lshlrev_b32 v62, 16, v49
    v_and_b32 v63, 0xffff0000, v49
    v_add_f32 v26, v26, v62
    v_add_f32 v27, v27, v63
    v_lshlrev_b32 v60, 16, v50
    v_and_b32 v61, 0xffff0000, v50
    v_add_f32 v28, v28, v60
    v_add_f32 v29, v29, v61
    v_lshlrev_b32 v62, 16, v51
    v_and_b32 v63, 0xffff0000, v51
    v_add_f32 v30, v30, v62
    v_add_f32 v31, v31, v63
    v_lshlrev_b32 v60, 16, v52
    v_and_b32 v61, 0xffff0000, v52
    v_add_f32 v32, v32, v60
    v_add_f32 v33, v33, v61
    v_lshlrev_b32 v62, 16, v53
    v_and_b32 v63, 0xffff0000, v53
    v_add_f32 v34, v34, v62
    v_add_f32 v35, v35, v63
    v_lshlrev_b32 v60, 16, v54
    v_and_b32 v61, 0xffff0000, v54
    v_add_f32 v36, v36, v60
    v_add_f32 v37, v37, v61
    v_lshlrev_b32 v62, 16, v55
    v_and_b32 v63, 0xffff0000, v55
    v_add_f32 v38, v38, v62
    v_add_f32 v39, v39, v63
    v_lshlrev_b32 v60, 16, v56
    v_and_b32 v61, 0xffff0000, v56
    v_add_f32 v40, v40, v60
    v_add_f32 v41, v41, v61
    v_lshlrev_b32 v62, 16, v57
    v_and_b32 v63, 0xffff0000, v57
    v_add_f32 v42, v42, v62
    v_add_f32 v43, v43, v63
    v_lshlrev_b32 v60, 16, v58
    v_and_b32 v61, 0xffff0000, v58
    v_add_f32 v44, v44, v60
    v_add_f32 v45, v45, v61
    v_lshlrev_b32 v62, 16, v59
    v_and_b32 v63, 0xffff0000, v59
    v_add_f32 v46, v46, v62
    v_add_f32 v47, v47, v63
    ds_read_b128 v[48:51], v21 offset:0
    ds_read_b128 v[52:55], v21 offset:32
    ds_read_b128 v[56:59], v21 offset:64
    s_add_u32 s48, s48, 1
    s_cmp_eq_u32 s48, 5
    s_mov_b32 s45, 12288
    s_cselect_b32 s45, 4294918144, s45
    s_cselect_b32 s48, 0, s48
    v_add_u32 v21, s45, v21
    s_waitcnt lgkmcnt(0)
    v_lshlrev_b32 v60, 16, v48
    v_and_b32 v61, 0xffff0000, v48
    v_add_f32 v24, v24, v60
    v_add_f32 v25, v25, v61
    v_lshlrev_b32 v62, 16, v49
    v_and_b32 v63, 0xffff0000, v49
    v_add_f32 v26, v26, v62
    v_add_f32 v27, v27, v63
    v_lshlrev_b32 v60, 16, v50
    v_and_b32 v61, 0xffff0000, v50
    v_add_f32 v28, v28, v60
    v_add_f32 v29, v29, v61
    v_lshlrev_b32 v62, 16, v51
    v_and_b32 v63, 0xffff0000, v51
    v_add_f32 v30, v30, v62
    v_add_f32 v31, v31, v63
    v_lshlrev_b32 v60, 16, v52
    v_and_b32 v61, 0xffff0000, v52
    v_add_f32 v32, v32, v60
    v_add_f32 v33, v33, v61
    v_lshlrev_b32 v62, 16, v53
    v_and_b32 v63, 0xffff0000, v53
    v_add_f32 v34, v34, v62
    v_add_f32 v35, v35, v63
    v_lshlrev_b32 v60, 16, v54
    v_and_b32 v61, 0xffff0000, v54
    v_add_f32 v36, v36, v60
    v_add_f32 v37, v37, v61
    v_lshlrev_b32 v62, 16, v55
    v_and_b32 v63, 0xffff0000, v55
    v_add_f32 v38, v38, v62
    v_add_f32 v39, v39, v63
    v_lshlrev_b32 v60, 16, v56
    v_and_b32 v61, 0xffff0000, v56
    v_add_f32 v40, v40, v60
    v_add_f32 v41, v41, v61
    v_lshlrev_b32 v62, 16, v57
    v_and_b32 v63, 0xffff0000, v57
    v_add_f32 v42, v42, v62
    v_add_f32 v43, v43, v63
    v_lshlrev_b32 v60, 16, v58
    v_and_b32 v61, 0xffff0000, v58
    v_add_f32 v44, v44, v60
    v_add_f32 v45, v45, v61
    v_lshlrev_b32 v62, 16, v59
    v_and_b32 v63, 0xffff0000, v59
    v_add_f32 v46, v46, v62
    v_add_f32 v47, v47, v63
    s_waitcnt vmcnt(0)
    s_cmp_eq_u32 s57, 1
    s_cbranch_scc1 L_parallel_sum__mha_block__glu_gated_bilinear__prompt_kernel_pglu_st18
    s_mov_b32 s51, 200
L_parallel_sum__mha_block__glu_gated_bilinear__prompt_kernel_pglu_poll:
    buffer_load_dwordx2 v[64:65], v66, s[52:55], s50 offen sc1
    s_waitcnt vmcnt(0)
    v_and_b32 v64, v64, v65
    s_nop 0
    v_readfirstlane_b32 s56, v64
    s_cmp_eq_u32 s56, 1
    s_cbranch_scc1 L_parallel_sum__mha_block__glu_gated_bilinear__prompt_kernel_pglu_have
    s_sleep 8
    s_sub_u32 s51, s51, 1
    s_cmp_lg_u32 s51, 0
    s_cbranch_scc1 L_parallel_sum__mha_block__glu_gated_bilinear__prompt_kernel_pglu_poll
    s_lshl_b32 s56, s23, 6
    v_add_u32 v67, s56, v1
    v_mul_u32_u24 v67, 1280, v67
    v_mov_b32 v72, 0
    v_mov_b32 v73, 0
    v_mov_b32 v74, 0
    v_mov_b32 v75, 0
    v_mov_b32 v76, 0x3f803f80
    s_mov_b32 s56, 0
L_parallel_sum__mha_block__glu_gated_bilinear__prompt_kernel_pglu_fb:
    buffer_load_dwordx4 v[68:71], v67, s[8:11], s56 offen
    s_waitcnt vmcnt(0)
    v_dot2_f32_bf16 v72, v68, v76, v72
    v_dot2_f32_bf16 v74, v68, v68, v74
    v_dot2_f32_bf16 v73, v69, v76, v73
    v_dot2_f32_bf16 v75, v69, v69, v75
    v_dot2_f32_bf16 v72, v70, v76, v72
    v_dot2_f32_bf16 v74, v70, v70, v74
    v_dot2_f32_bf16 v73, v71, v76, v73
    v_dot2_f32_bf16 v75, v71, v71, v75
    s_add_u32 s56, s56, 16
    s_cmp_lt_u32 s56, 1280
    s_cbranch_scc1 L_parallel_sum__mha_block__glu_gated_bilinear__prompt_kernel_pglu_fb
    s_nop 3
    v_add_f32 v72, v72, v73
    v_add_f32 v74, v74, v75
    v_mul_f32 v64, 986500301, v72
    v_mul_f32 v74, 986500301, v74
    v_fma_f32 v74, -v64, v64, v74
    v_max_f32 v74, 0, v74
    v_add_f32 v74, 925353388, v74
    v_rsq_f32 v65, v74
    s_branch L_parallel_sum__mha_block__glu_gated_bilinear__prompt_kernel_pglu_wst
L_parallel_sum__mha_block__glu_gated_bilinear__prompt_kernel_pglu_have:
    buffer_load_dwordx2 v[64:65], v77, s[16:19], s58 offen sc1
    s_waitcnt vmcnt(0)
L_parallel_sum__mha_block__glu_gated_bilinear__prompt_kernel_pglu_wst:
    ds_write_b32 v78, v64 offset:0
    ds_write_b32 v78, v65 offset:1024
L_parallel_sum__mha_block__glu_gated_bilinear__prompt_kernel_pglu_st18:
    s_waitcnt lgkmcnt(0)
    s_barrier
    ds_read_b128 v[48:51], v21 offset:0
    ds_read_b128 v[52:55], v21 offset:32
    ds_read_b128 v[56:59], v21 offset:64
    s_add_u32 s48, s48, 1
    s_cmp_eq_u32 s48, 5
    s_mov_b32 s45, 12288
    s_cselect_b32 s45, 4294918144, s45
    s_cselect_b32 s48, 0, s48
    v_add_u32 v21, s45, v21
    s_waitcnt lgkmcnt(0)
    v_lshlrev_b32 v60, 16, v48
    v_and_b32 v61, 0xffff0000, v48
    v_add_f32 v24, v24, v60
    v_add_f32 v25, v25, v61
    v_lshlrev_b32 v62, 16, v49
    v_and_b32 v63, 0xffff0000, v49
    v_add_f32 v26, v26, v62
    v_add_f32 v27, v27, v63
    v_lshlrev_b32 v60, 16, v50
    v_and_b32 v61, 0xffff0000, v50
    v_add_f32 v28, v28, v60
    v_add_f32 v29, v29, v61
    v_lshlrev_b32 v62, 16, v51
    v_and_b32 v63, 0xffff0000, v51
    v_add_f32 v30, v30, v62
    v_add_f32 v31, v31, v63
    v_lshlrev_b32 v60, 16, v52
    v_and_b32 v61, 0xffff0000, v52
    v_add_f32 v32, v32, v60
    v_add_f32 v33, v33, v61
    v_lshlrev_b32 v62, 16, v53
    v_and_b32 v63, 0xffff0000, v53
    v_add_f32 v34, v34, v62
    v_add_f32 v35, v35, v63
    v_lshlrev_b32 v60, 16, v54
    v_and_b32 v61, 0xffff0000, v54
    v_add_f32 v36, v36, v60
    v_add_f32 v37, v37, v61
    v_lshlrev_b32 v62, 16, v55
    v_and_b32 v63, 0xffff0000, v55
    v_add_f32 v38, v38, v62
    v_add_f32 v39, v39, v63
    v_lshlrev_b32 v60, 16, v56
    v_and_b32 v61, 0xffff0000, v56
    v_add_f32 v40, v40, v60
    v_add_f32 v41, v41, v61
    v_lshlrev_b32 v62, 16, v57
    v_and_b32 v63, 0xffff0000, v57
    v_add_f32 v42, v42, v62
    v_add_f32 v43, v43, v63
    v_lshlrev_b32 v60, 16, v58
    v_and_b32 v61, 0xffff0000, v58
    v_add_f32 v44, v44, v60
    v_add_f32 v45, v45, v61
    v_lshlrev_b32 v62, 16, v59
    v_and_b32 v63, 0xffff0000, v59
    v_add_f32 v46, v46, v62
    v_add_f32 v47, v47, v63
    s_waitcnt vmcnt(0)
    s_add_u32 s26, s27, 35840
    v_mul_u32_u24 v2, 96, v1
    v_add_u32 v2, s26, v2
    ds_write_b128 v2, v[24:27] offset:0
    ds_write_b128 v2, v[28:31] offset:16
    ds_write_b128 v2, v[32:35] offset:32
    ds_write_b128 v2, v[36:39] offset:48
    ds_write_b128 v2, v[40:43] offset:64
    ds_write_b128 v2, v[44:47] offset:80
    v_lshrrev_b32 v3, 4, v1
    v_lshlrev_b32 v3, 5, v3
    v_bfe_u32 v4, v1, 3, 1
    v_mul_u32_u24 v4, 96, v4
    v_and_b32 v5, 7, v1
    v_lshlrev_b32 v5, 2, v5
    v_add3_u32 v3, v3, v4, v5
    v_min_u32 v3, 188, v3
    v_add_u32 v3, s26, v3
    s_waitcnt lgkmcnt(0)
    ds_read_b32 v24, v3 offset:0
    ds_read_b32 v25, v3 offset:192
    ds_read_b32 v26, v3 offset:384
    ds_read_b32 v27, v3 offset:576
    ds_read_b32 v28, v3 offset:768
    ds_read_b32 v29, v3 offset:960
    ds_read_b32 v30, v3 offset:1152
    ds_read_b32 v31, v3 offset:1344
    ds_read_b32 v32, v3 offset:1536
    ds_read_b32 v33, v3 offset:1728
    ds_read_b32 v34, v3 offset:1920
    ds_read_b32 v35, v3 offset:2112
    ds_read_b32 v36, v3 offset:2304
    ds_read_b32 v37, v3 offset:2496
    ds_read_b32 v38, v3 offset:2688
    ds_read_b32 v39, v3 offset:2880
    ds_read_b32 v48, v3 offset:3072
    ds_read_b32 v49, v3 offset:3264
    ds_read_b32 v50, v3 offset:3456
    ds_read_b32 v51, v3 offset:3648
    ds_read_b32 v52, v3 offset:3840
    ds_read_b32 v53, v3 offset:4032
    ds_read_b32 v54, v3 offset:4224
    ds_read_b32 v55, v3 offset:4416
    ds_read_b32 v56, v3 offset:4608
    ds_read_b32 v57, v3 offset:4800
    ds_read_b32 v58, v3 offset:4992
    ds_read_b32 v59, v3 offset:5184
    ds_read_b32 v60, v3 offset:5376
    ds_read_b32 v61, v3 offset:5568
    ds_read_b32 v62, v3 offset:5760
    ds_read_b32 v63, v3 offset:5952
    s_barrier
    s_waitcnt lgkmcnt(0)
    v_add_f32 v24, v24, v48
    v_add_f32 v25, v25, v49
    v_add_f32 v26, v26, v50
    v_add_f32 v27, v27, v51
    v_add_f32 v28, v28, v52
    v_add_f32 v29, v29, v53
    v_add_f32 v30, v30, v54
    v_add_f32 v31, v31, v55
    v_add_f32 v32, v32, v56
    v_add_f32 v33, v33, v57
    v_add_f32 v34, v34, v58
    v_add_f32 v35, v35, v59
    v_add_f32 v36, v36, v60
    v_add_f32 v37, v37, v61
    v_add_f32 v38, v38, v62
    v_add_f32 v39, v39, v63
    v_add_f32 v24, v24, v32
    v_add_f32 v25, v25, v33
    v_add_f32 v26, v26, v34
    v_add_f32 v27, v27, v35
    v_add_f32 v28, v28, v36
    v_add_f32 v29, v29, v37
    v_add_f32 v30, v30, v38
    v_add_f32 v31, v31, v39
    v_add_f32 v24, v24, v28
    v_add_f32 v25, v25, v29
    v_add_f32 v26, v26, v30
    v_add_f32 v27, v27, v31
    v_add_f32 v24, v24, v26
    v_add_f32 v25, v25, v27
    v_add_f32 v24, v24, v25
    s_mul_i32 s26, s23, 192
    v_lshlrev_b32 v2, 2, v1
    v_add_u32 v2, s26, v2
    v_cmp_gt_u32 vcc, 48, v1
    s_and_saveexec_b64 s[30:31], vcc
    ds_write_b32 v2, v24 offset:2048
    s_mov_b64 exec, s[30:31]
    s_waitcnt lgkmcnt(0)
    s_barrier
    s_endpgm
L_parallel_sum__mha_block__glu_gated_bilinear__prompt_kernel_relay:
    s_sub_u32 s24, s21, 30
    s_lshl_b32 s24, s24, 3
    s_add_u32 s24, s24, s20
    s_lshl_b32 s25, s24, 7
    s_lshl_b32 s26, s22, 4
    s_add_u32 s25, s25, s26
    s_mul_i32 s26, s25, 1280
    s_mov_b32 s8, s68
    s_mov_b32 s9, s69
    s_mov_b32 s10, 2621440
    s_mov_b32 s11, 0x20000
    v_lshrrev_b32 v2, 2, v1
    v_mul_u32_u24 v3, 1280, v2
    v_and_b32 v4, 3, v1
    v_lshlrev_b32 v4, 4, v4
    v_add_u32 v3, v3, v4
    buffer_load_dwordx4 v[32:35], v3, s[8:11], s26 offen offset:0
    buffer_load_dwordx4 v[36:39], v3, s[8:11], s26 offen offset:64
    buffer_load_dwordx4 v[40:43], v3, s[8:11], s26 offen offset:128
    buffer_load_dwordx4 v[44:47], v3, s[8:11], s26 offen offset:192
    buffer_load_dwordx4 v[48:51], v3, s[8:11], s26 offen offset:256
    buffer_load_dwordx4 v[52:55], v3, s[8:11], s26 offen offset:320
    buffer_load_dwordx4 v[56:59], v3, s[8:11], s26 offen offset:384
    buffer_load_dwordx4 v[60:63], v3, s[8:11], s26 offen offset:448
    buffer_load_dwordx4 v[64:67], v3, s[8:11], s26 offen offset:512
    buffer_load_dwordx4 v[68:71], v3, s[8:11], s26 offen offset:576
    buffer_load_dwordx4 v[72:75], v3, s[8:11], s26 offen offset:640
    buffer_load_dwordx4 v[76:79], v3, s[8:11], s26 offen offset:704
    buffer_load_dwordx4 v[80:83], v3, s[8:11], s26 offen offset:768
    buffer_load_dwordx4 v[84:87], v3, s[8:11], s26 offen offset:832
    buffer_load_dwordx4 v[88:91], v3, s[8:11], s26 offen offset:896
    buffer_load_dwordx4 v[92:95], v3, s[8:11], s26 offen offset:960
    buffer_load_dwordx4 v[96:99], v3, s[8:11], s26 offen offset:1024
    buffer_load_dwordx4 v[100:103], v3, s[8:11], s26 offen offset:1088
    buffer_load_dwordx4 v[104:107], v3, s[8:11], s26 offen offset:1152
    buffer_load_dwordx4 v[108:111], v3, s[8:11], s26 offen offset:1216
    v_mov_b32 v20, 0
    v_mov_b32 v21, 0
    v_mov_b32 v22, 0
    v_mov_b32 v23, 0
    v_mov_b32 v26, 0x3f803f80
    s_waitcnt vmcnt(19)
    v_dot2_f32_bf16 v20, v32, v26, v20
    v_dot2_f32_bf16 v22, v32, v32, v22
    v_dot2_f32_bf16 v21, v33, v26, v21
    v_dot2_f32_bf16 v23, v33, v33, v23
    v_dot2_f32_bf16 v20, v34, v26, v20
    v_dot2_f32_bf16 v22, v34, v34, v22
    v_dot2_f32_bf16 v21, v35, v26, v21
    v_dot2_f32_bf16 v23, v35, v35, v23
    s_waitcnt vmcnt(18)
    v_dot2_f32_bf16 v20, v36, v26, v20
    v_dot2_f32_bf16 v22, v36, v36, v22
    v_dot2_f32_bf16 v21, v37, v26, v21
    v_dot2_f32_bf16 v23, v37, v37, v23
    v_dot2_f32_bf16 v20, v38, v26, v20
    v_dot2_f32_bf16 v22, v38, v38, v22
    v_dot2_f32_bf16 v21, v39, v26, v21
    v_dot2_f32_bf16 v23, v39, v39, v23
    s_waitcnt vmcnt(17)
    v_dot2_f32_bf16 v20, v40, v26, v20
    v_dot2_f32_bf16 v22, v40, v40, v22
    v_dot2_f32_bf16 v21, v41, v26, v21
    v_dot2_f32_bf16 v23, v41, v41, v23
    v_dot2_f32_bf16 v20, v42, v26, v20
    v_dot2_f32_bf16 v22, v42, v42, v22
    v_dot2_f32_bf16 v21, v43, v26, v21
    v_dot2_f32_bf16 v23, v43, v43, v23
    s_waitcnt vmcnt(16)
    v_dot2_f32_bf16 v20, v44, v26, v20
    v_dot2_f32_bf16 v22, v44, v44, v22
    v_dot2_f32_bf16 v21, v45, v26, v21
    v_dot2_f32_bf16 v23, v45, v45, v23
    v_dot2_f32_bf16 v20, v46, v26, v20
    v_dot2_f32_bf16 v22, v46, v46, v22
    v_dot2_f32_bf16 v21, v47, v26, v21
    v_dot2_f32_bf16 v23, v47, v47, v23
    s_waitcnt vmcnt(15)
    v_dot2_f32_bf16 v20, v48, v26, v20
    v_dot2_f32_bf16 v22, v48, v48, v22
    v_dot2_f32_bf16 v21, v49, v26, v21
    v_dot2_f32_bf16 v23, v49, v49, v23
    v_dot2_f32_bf16 v20, v50, v26, v20
    v_dot2_f32_bf16 v22, v50, v50, v22
    v_dot2_f32_bf16 v21, v51, v26, v21
    v_dot2_f32_bf16 v23, v51, v51, v23
    s_waitcnt vmcnt(14)
    v_dot2_f32_bf16 v20, v52, v26, v20
    v_dot2_f32_bf16 v22, v52, v52, v22
    v_dot2_f32_bf16 v21, v53, v26, v21
    v_dot2_f32_bf16 v23, v53, v53, v23
    v_dot2_f32_bf16 v20, v54, v26, v20
    v_dot2_f32_bf16 v22, v54, v54, v22
    v_dot2_f32_bf16 v21, v55, v26, v21
    v_dot2_f32_bf16 v23, v55, v55, v23
    s_waitcnt vmcnt(13)
    v_dot2_f32_bf16 v20, v56, v26, v20
    v_dot2_f32_bf16 v22, v56, v56, v22
    v_dot2_f32_bf16 v21, v57, v26, v21
    v_dot2_f32_bf16 v23, v57, v57, v23
    v_dot2_f32_bf16 v20, v58, v26, v20
    v_dot2_f32_bf16 v22, v58, v58, v22
    v_dot2_f32_bf16 v21, v59, v26, v21
    v_dot2_f32_bf16 v23, v59, v59, v23
    s_waitcnt vmcnt(12)
    v_dot2_f32_bf16 v20, v60, v26, v20
    v_dot2_f32_bf16 v22, v60, v60, v22
    v_dot2_f32_bf16 v21, v61, v26, v21
    v_dot2_f32_bf16 v23, v61, v61, v23
    v_dot2_f32_bf16 v20, v62, v26, v20
    v_dot2_f32_bf16 v22, v62, v62, v22
    v_dot2_f32_bf16 v21, v63, v26, v21
    v_dot2_f32_bf16 v23, v63, v63, v23
    s_waitcnt vmcnt(11)
    v_dot2_f32_bf16 v20, v64, v26, v20
    v_dot2_f32_bf16 v22, v64, v64, v22
    v_dot2_f32_bf16 v21, v65, v26, v21
    v_dot2_f32_bf16 v23, v65, v65, v23
    v_dot2_f32_bf16 v20, v66, v26, v20
    v_dot2_f32_bf16 v22, v66, v66, v22
    v_dot2_f32_bf16 v21, v67, v26, v21
    v_dot2_f32_bf16 v23, v67, v67, v23
    s_waitcnt vmcnt(10)
    v_dot2_f32_bf16 v20, v68, v26, v20
    v_dot2_f32_bf16 v22, v68, v68, v22
    v_dot2_f32_bf16 v21, v69, v26, v21
    v_dot2_f32_bf16 v23, v69, v69, v23
    v_dot2_f32_bf16 v20, v70, v26, v20
    v_dot2_f32_bf16 v22, v70, v70, v22
    v_dot2_f32_bf16 v21, v71, v26, v21
    v_dot2_f32_bf16 v23, v71, v71, v23
    s_waitcnt vmcnt(9)
    v_dot2_f32_bf16 v20, v72, v26, v20
    v_dot2_f32_bf16 v22, v72, v72, v22
    v_dot2_f32_bf16 v21, v73, v26, v21
    v_dot2_f32_bf16 v23, v73, v73, v23
    v_dot2_f32_bf16 v20, v74, v26, v20
    v_dot2_f32_bf16 v22, v74, v74, v22
    v_dot2_f32_bf16 v21, v75, v26, v21
    v_dot2_f32_bf16 v23, v75, v75, v23
    s_waitcnt vmcnt(8)
    v_dot2_f32_bf16 v20, v76, v26, v20
    v_dot2_f32_bf16 v22, v76, v76, v22
    v_dot2_f32_bf16 v21, v77, v26, v21
    v_dot2_f32_bf16 v23, v77, v77, v23
    v_dot2_f32_bf16 v20, v78, v26, v20
    v_dot2_f32_bf16 v22, v78, v78, v22
    v_dot2_f32_bf16 v21, v79, v26, v21
    v_dot2_f32_bf16 v23, v79, v79, v23
    s_waitcnt vmcnt(7)
    v_dot2_f32_bf16 v20, v80, v26, v20
    v_dot2_f32_bf16 v22, v80, v80, v22
    v_dot2_f32_bf16 v21, v81, v26, v21
    v_dot2_f32_bf16 v23, v81, v81, v23
    v_dot2_f32_bf16 v20, v82, v26, v20
    v_dot2_f32_bf16 v22, v82, v82, v22
    v_dot2_f32_bf16 v21, v83, v26, v21
    v_dot2_f32_bf16 v23, v83, v83, v23
    s_waitcnt vmcnt(6)
    v_dot2_f32_bf16 v20, v84, v26, v20
    v_dot2_f32_bf16 v22, v84, v84, v22
    v_dot2_f32_bf16 v21, v85, v26, v21
    v_dot2_f32_bf16 v23, v85, v85, v23
    v_dot2_f32_bf16 v20, v86, v26, v20
    v_dot2_f32_bf16 v22, v86, v86, v22
    v_dot2_f32_bf16 v21, v87, v26, v21
    v_dot2_f32_bf16 v23, v87, v87, v23
    s_waitcnt vmcnt(5)
    v_dot2_f32_bf16 v20, v88, v26, v20
    v_dot2_f32_bf16 v22, v88, v88, v22
    v_dot2_f32_bf16 v21, v89, v26, v21
    v_dot2_f32_bf16 v23, v89, v89, v23
    v_dot2_f32_bf16 v20, v90, v26, v20
    v_dot2_f32_bf16 v22, v90, v90, v22
    v_dot2_f32_bf16 v21, v91, v26, v21
    v_dot2_f32_bf16 v23, v91, v91, v23
    s_waitcnt vmcnt(4)
    v_dot2_f32_bf16 v20, v92, v26, v20
    v_dot2_f32_bf16 v22, v92, v92, v22
    v_dot2_f32_bf16 v21, v93, v26, v21
    v_dot2_f32_bf16 v23, v93, v93, v23
    v_dot2_f32_bf16 v20, v94, v26, v20
    v_dot2_f32_bf16 v22, v94, v94, v22
    v_dot2_f32_bf16 v21, v95, v26, v21
    v_dot2_f32_bf16 v23, v95, v95, v23
    s_waitcnt vmcnt(3)
    v_dot2_f32_bf16 v20, v96, v26, v20
    v_dot2_f32_bf16 v22, v96, v96, v22
    v_dot2_f32_bf16 v21, v97, v26, v21
    v_dot2_f32_bf16 v23, v97, v97, v23
    v_dot2_f32_bf16 v20, v98, v26, v20
    v_dot2_f32_bf16 v22, v98, v98, v22
    v_dot2_f32_bf16 v21, v99, v26, v21
    v_dot2_f32_bf16 v23, v99, v99, v23
    s_waitcnt vmcnt(2)
    v_dot2_f32_bf16 v20, v100, v26, v20
    v_dot2_f32_bf16 v22, v100, v100, v22
    v_dot2_f32_bf16 v21, v101, v26, v21
    v_dot2_f32_bf16 v23, v101, v101, v23
    v_dot2_f32_bf16 v20, v102, v26, v20
    v_dot2_f32_bf16 v22, v102, v102, v22
    v_dot2_f32_bf16 v21, v103, v26, v21
    v_dot2_f32_bf16 v23, v103, v103, v23
    s_waitcnt vmcnt(1)
    v_dot2_f32_bf16 v20, v104, v26, v20
    v_dot2_f32_bf16 v22, v104, v104, v22
    v_dot2_f32_bf16 v21, v105, v26, v21
    v_dot2_f32_bf16 v23, v105, v105, v23
    v_dot2_f32_bf16 v20, v106, v26, v20
    v_dot2_f32_bf16 v22, v106, v106, v22
    v_dot2_f32_bf16 v21, v107, v26, v21
    v_dot2_f32_bf16 v23, v107, v107, v23
    s_waitcnt vmcnt(0)
    v_dot2_f32_bf16 v20, v108, v26, v20
    v_dot2_f32_bf16 v22, v108, v108, v22
    v_dot2_f32_bf16 v21, v109, v26, v21
    v_dot2_f32_bf16 v23, v109, v109, v23
    v_dot2_f32_bf16 v20, v110, v26, v20
    v_dot2_f32_bf16 v22, v110, v110, v22
    v_dot2_f32_bf16 v21, v111, v26, v21
    v_dot2_f32_bf16 v23, v111, v111, v23
    s_nop 3
    v_add_f32 v20, v20, v21
    v_add_f32 v22, v22, v23
    s_nop 1
    v_add_f32_dpp v20, v20, v20 quad_perm:[1,0,3,2] row_mask:0xf bank_mask:0xf
    v_add_f32_dpp v22, v22, v22 quad_perm:[1,0,3,2] row_mask:0xf bank_mask:0xf
    s_nop 1
    v_add_f32_dpp v20, v20, v20 quad_perm:[2,3,0,1] row_mask:0xf bank_mask:0xf
    v_add_f32_dpp v22, v22, v22 quad_perm:[2,3,0,1] row_mask:0xf bank_mask:0xf
    s_nop 1
    v_mul_f32 v24, 986500301, v20
    v_mul_f32 v22, 986500301, v22
    v_fma_f32 v22, -v24, v24, v22
    v_max_f32 v22, 0, v22
    v_add_f32 v22, 925353388, v22
    v_rsq_f32 v25, v22
    v_lshlrev_b32 v2, 3, v2
    s_lshl_b32 s25, s25, 3
    s_add_u32 s25, s25, 23216128
    s_mov_b32 s28, 0x11111111
    s_mov_b32 s29, 0x11111111
    s_mov_b64 exec, s[28:29]
    buffer_store_dwordx2 v[24:25], v2, s[16:19], s25 offen sc1
    s_mov_b64 exec, -1
    s_waitcnt vmcnt(0)
    s_barrier
    s_cmp_lg_u32 s22, 0
    s_cbranch_scc1 L_parallel_sum__mha_block__glu_gated_bilinear__prompt_kernel_rs_done
    s_mov_b32 s8, s84
    s_mov_b32 s9, s85
    s_mov_b32 s10, 256
    s_mov_b32 s11, 0x20000
    s_lshl_b32 s24, s24, 2
    v_mov_b32 v2, 0
    v_mov_b32 v3, 1
    s_mov_b64 exec, 1
    buffer_store_dword v3, v2, s[8:11], s24 offen sc1
    s_mov_b64 exec, -1
L_parallel_sum__mha_block__glu_gated_bilinear__prompt_kernel_rs_done:
    s_sub_u32 s24, s21, 30
    s_lshl_b32 s24, s24, 3
    s_add_u32 s24, s24, s20
    s_lshl_b32 s24, s24, 3
    s_add_u32 s24, s24, s22
    s_mul_i32 s24, s24, 24
    s_mov_b32 s8, s80
    s_mov_b32 s9, s81
    s_mov_b32 s10, 2211840
    s_mov_b32 s11, 0x20000
    s_mov_b32 s12, s72
    s_mov_b32 s13, s73
    s_mov_b32 s14, 819200
    s_mov_b32 s15, 0x20000
    s_mul_i32 s25, s22, 12288
    v_lshrrev_b32 v2, 2, v1
    v_and_b32 v3, 3, v1
    v_lshlrev_b32 v3, 4, v3
    v_mul_u32_u24 v4, 1280, v2
    v_add_u32 v10, v4, v3
    v_lshrrev_b32 v4, 3, v2
    v_bfe_u32 v5, v2, 2, 1
    v_lshlrev_b32 v5, 1, v5
    v_add_u32 v4, v4, v5
    v_mul_u32_u24 v4, 20, v4
    v_and_b32 v5, 3, v2
    v_add_u32 v4, v4, v5
    v_mul_u32_u24 v4, 1280, v4
    v_add_u32 v11, v4, v3
    v_lshrrev_b32 v3, 5, v1
    v_bfe_u32 v7, v1, 2, 2
    v_lshlrev_b32 v8, 2, v3
    v_add_u32 v7, v7, v8
    v_lshlrev_b32 v7, 6, v7
    v_bfe_u32 v8, v1, 4, 1
    v_lshlrev_b32 v8, 5, v8
    v_and_b32 v9, 3, v1
    v_lshlrev_b32 v9, 3, v9
    v_add_u32 v7, v7, v8
    v_add_u32 v7, v7, v9
    v_add_u32 v12, s25, v7
    v_lshlrev_b32 v13, 4, v1
    s_mov_b32 s26, 0
L_parallel_sum__mha_block__glu_gated_bilinear__prompt_kernel_rl_batch:
    s_mov_b32 s27, 0
L_parallel_sum__mha_block__glu_gated_bilinear__prompt_kernel_rl_ld:
    s_add_u32 s28, s24, s27
    s_mul_i32 s29, s28, 3277
    s_lshr_b32 s29, s29, 16
    s_mul_i32 s30, s29, 20
    s_sub_u32 s30, s28, s30
    s_lshl_b32 s30, s30, 6
    s_lshl_b32 s31, s27, 10
    s_add_u32 m0, s25, s31
    s_cmp_ge_u32 s29, 140
    s_cbranch_scc1 L_parallel_sum__mha_block__glu_gated_bilinear__prompt_kernel_rl_left
    s_cmp_ge_u32 s29, 108
    s_cbranch_scc1 L_parallel_sum__mha_block__glu_gated_bilinear__prompt_kernel_rl_wo
    s_mul_i32 s31, s29, 20480
    s_add_u32 s31, s31, s30
    buffer_load_dwordx4 v10, s[8:11], s31 offen lds
    s_branch L_parallel_sum__mha_block__glu_gated_bilinear__prompt_kernel_rl_next
L_parallel_sum__mha_block__glu_gated_bilinear__prompt_kernel_rl_wo:
    s_sub_u32 s31, s29, 108
    s_mul_i32 s31, s31, 25600
    s_add_u32 s31, s31, s30
    buffer_load_dwordx4 v10, s[12:15], s31 offen lds
    s_branch L_parallel_sum__mha_block__glu_gated_bilinear__prompt_kernel_rl_next
L_parallel_sum__mha_block__glu_gated_bilinear__prompt_kernel_rl_left:
    s_sub_u32 s31, s29, 140
    s_mul_i32 s31, s31, 102400
    s_add_u32 s31, s31, 20480
    s_add_u32 s31, s31, s30
    buffer_load_dwordx4 v11, s[12:15], s31 offen lds
L_parallel_sum__mha_block__glu_gated_bilinear__prompt_kernel_rl_next:
    s_add_u32 s27, s27, 1
    s_cmp_lt_u32 s27, 12
    s_cbranch_scc1 L_parallel_sum__mha_block__glu_gated_bilinear__prompt_kernel_rl_ld
    s_waitcnt vmcnt(0)
    ds_read_b64_tr_b16 v[16:17], v12 offset:0
    ds_read_b64_tr_b16 v[18:19], v12 offset:512
    ds_read_b64_tr_b16 v[20:21], v12 offset:1024
    ds_read_b64_tr_b16 v[22:23], v12 offset:1536
    ds_read_b64_tr_b16 v[24:25], v12 offset:2048
    ds_read_b64_tr_b16 v[26:27], v12 offset:2560
    ds_read_b64_tr_b16 v[28:29], v12 offset:3072
    ds_read_b64_tr_b16 v[30:31], v12 offset:3584
    ds_read_b64_tr_b16 v[32:33], v12 offset:4096
    ds_read_b64_tr_b16 v[34:35], v12 offset:4608
    ds_read_b64_tr_b16 v[36:37], v12 offset:5120
    ds_read_b64_tr_b16 v[38:39], v12 offset:5632
    ds_read_b64_tr_b16 v[40:41], v12 offset:6144
    ds_read_b64_tr_b16 v[42:43], v12 offset:6656
    ds_read_b64_tr_b16 v[44:45], v12 offset:7168
    ds_read_b64_tr_b16 v[46:47], v12 offset:7680
    ds_read_b64_tr_b16 v[48:49], v12 offset:8192
    ds_read_b64_tr_b16 v[50:51], v12 offset:8704
    ds_read_b64_tr_b16 v[52:53], v12 offset:9216
    ds_read_b64_tr_b16 v[54:55], v12 offset:9728
    ds_read_b64_tr_b16 v[56:57], v12 offset:10240
    ds_read_b64_tr_b16 v[58:59], v12 offset:10752
    ds_read_b64_tr_b16 v[60:61], v12 offset:11264
    ds_read_b64_tr_b16 v[62:63], v12 offset:11776
    s_waitcnt lgkmcnt(0)
    s_add_u32 s28, s24, 0
    s_mul_i32 s29, s28, 3277
    s_lshr_b32 s29, s29, 16
    s_mul_i32 s30, s29, 20
    s_sub_u32 s30, s28, s30
    s_mul_i32 s30, s30, 148
    s_add_u32 s30, s30, s29
    s_lshl_b32 s30, s30, 10
    s_add_u32 s30, s30, 17563648
    s_cmp_lt_u32 s28, 2960
    s_cselect_b32 s30, s30, 0x40000000
    buffer_store_dwordx4 v[16:19], v13, s[16:19], s30 offen sc0 sc1
    s_add_u32 s28, s24, 1
    s_mul_i32 s29, s28, 3277
    s_lshr_b32 s29, s29, 16
    s_mul_i32 s30, s29, 20
    s_sub_u32 s30, s28, s30
    s_mul_i32 s30, s30, 148
    s_add_u32 s30, s30, s29
    s_lshl_b32 s30, s30, 10
    s_add_u32 s30, s30, 17563648
    s_cmp_lt_u32 s28, 2960
    s_cselect_b32 s30, s30, 0x40000000
    buffer_store_dwordx4 v[20:23], v13, s[16:19], s30 offen sc0 sc1
    s_add_u32 s28, s24, 2
    s_mul_i32 s29, s28, 3277
    s_lshr_b32 s29, s29, 16
    s_mul_i32 s30, s29, 20
    s_sub_u32 s30, s28, s30
    s_mul_i32 s30, s30, 148
    s_add_u32 s30, s30, s29
    s_lshl_b32 s30, s30, 10
    s_add_u32 s30, s30, 17563648
    s_cmp_lt_u32 s28, 2960
    s_cselect_b32 s30, s30, 0x40000000
    buffer_store_dwordx4 v[24:27], v13, s[16:19], s30 offen sc0 sc1
    s_add_u32 s28, s24, 3
    s_mul_i32 s29, s28, 3277
    s_lshr_b32 s29, s29, 16
    s_mul_i32 s30, s29, 20
    s_sub_u32 s30, s28, s30
    s_mul_i32 s30, s30, 148
    s_add_u32 s30, s30, s29
    s_lshl_b32 s30, s30, 10
    s_add_u32 s30, s30, 17563648
    s_cmp_lt_u32 s28, 2960
    s_cselect_b32 s30, s30, 0x40000000
    buffer_store_dwordx4 v[28:31], v13, s[16:19], s30 offen sc0 sc1
    s_add_u32 s28, s24, 4
    s_mul_i32 s29, s28, 3277
    s_lshr_b32 s29, s29, 16
    s_mul_i32 s30, s29, 20
    s_sub_u32 s30, s28, s30
    s_mul_i32 s30, s30, 148
    s_add_u32 s30, s30, s29
    s_lshl_b32 s30, s30, 10
    s_add_u32 s30, s30, 17563648
    s_cmp_lt_u32 s28, 2960
    s_cselect_b32 s30, s30, 0x40000000
    buffer_store_dwordx4 v[32:35], v13, s[16:19], s30 offen sc0 sc1
    s_add_u32 s28, s24, 5
    s_mul_i32 s29, s28, 3277
    s_lshr_b32 s29, s29, 16
    s_mul_i32 s30, s29, 20
    s_sub_u32 s30, s28, s30
    s_mul_i32 s30, s30, 148
    s_add_u32 s30, s30, s29
    s_lshl_b32 s30, s30, 10
    s_add_u32 s30, s30, 17563648
    s_cmp_lt_u32 s28, 2960
    s_cselect_b32 s30, s30, 0x40000000
    buffer_store_dwordx4 v[36:39], v13, s[16:19], s30 offen sc0 sc1
    s_add_u32 s28, s24, 6
    s_mul_i32 s29, s28, 3277
    s_lshr_b32 s29, s29, 16
    s_mul_i32 s30, s29, 20
    s_sub_u32 s30, s28, s30
    s_mul_i32 s30, s30, 148
    s_add_u32 s30, s30, s29
    s_lshl_b32 s30, s30, 10
    s_add_u32 s30, s30, 17563648
    s_cmp_lt_u32 s28, 2960
    s_cselect_b32 s30, s30, 0x40000000
    buffer_store_dwordx4 v[40:43], v13, s[16:19], s30 offen sc0 sc1
    s_add_u32 s28, s24, 7
    s_mul_i32 s29, s28, 3277
    s_lshr_b32 s29, s29, 16
    s_mul_i32 s30, s29, 20
    s_sub_u32 s30, s28, s30
    s_mul_i32 s30, s30, 148
    s_add_u32 s30, s30, s29
    s_lshl_b32 s30, s30, 10
    s_add_u32 s30, s30, 17563648
    s_cmp_lt_u32 s28, 2960
    s_cselect_b32 s30, s30, 0x40000000
    buffer_store_dwordx4 v[44:47], v13, s[16:19], s30 offen sc0 sc1
    s_add_u32 s28, s24, 8
    s_mul_i32 s29, s28, 3277
    s_lshr_b32 s29, s29, 16
    s_mul_i32 s30, s29, 20
    s_sub_u32 s30, s28, s30
    s_mul_i32 s30, s30, 148
    s_add_u32 s30, s30, s29
    s_lshl_b32 s30, s30, 10
    s_add_u32 s30, s30, 17563648
    s_cmp_lt_u32 s28, 2960
    s_cselect_b32 s30, s30, 0x40000000
    buffer_store_dwordx4 v[48:51], v13, s[16:19], s30 offen sc0 sc1
    s_add_u32 s28, s24, 9
    s_mul_i32 s29, s28, 3277
    s_lshr_b32 s29, s29, 16
    s_mul_i32 s30, s29, 20
    s_sub_u32 s30, s28, s30
    s_mul_i32 s30, s30, 148
    s_add_u32 s30, s30, s29
    s_lshl_b32 s30, s30, 10
    s_add_u32 s30, s30, 17563648
    s_cmp_lt_u32 s28, 2960
    s_cselect_b32 s30, s30, 0x40000000
    buffer_store_dwordx4 v[52:55], v13, s[16:19], s30 offen sc0 sc1
    s_add_u32 s28, s24, 10
    s_mul_i32 s29, s28, 3277
    s_lshr_b32 s29, s29, 16
    s_mul_i32 s30, s29, 20
    s_sub_u32 s30, s28, s30
    s_mul_i32 s30, s30, 148
    s_add_u32 s30, s30, s29
    s_lshl_b32 s30, s30, 10
    s_add_u32 s30, s30, 17563648
    s_cmp_lt_u32 s28, 2960
    s_cselect_b32 s30, s30, 0x40000000
    buffer_store_dwordx4 v[56:59], v13, s[16:19], s30 offen sc0 sc1
    s_add_u32 s28, s24, 11
    s_mul_i32 s29, s28, 3277
    s_lshr_b32 s29, s29, 16
    s_mul_i32 s30, s29, 20
    s_sub_u32 s30, s28, s30
    s_mul_i32 s30, s30, 148
    s_add_u32 s30, s30, s29
    s_lshl_b32 s30, s30, 10
    s_add_u32 s30, s30, 17563648
    s_cmp_lt_u32 s28, 2960
    s_cselect_b32 s30, s30, 0x40000000
    buffer_store_dwordx4 v[60:63], v13, s[16:19], s30 offen sc0 sc1
    s_add_u32 s24, s24, 12
    s_add_u32 s26, s26, 1
    s_cmp_lt_u32 s26, 2
    s_cbranch_scc1 L_parallel_sum__mha_block__glu_gated_bilinear__prompt_kernel_rl_batch
L_parallel_sum__mha_block__glu_gated_bilinear__prompt_kernel_end:
    s_endpgm
.globl attn_kernel
.p2align 8
.type attn_kernel,@function
attn_kernel:
    s_cmp_ge_u32 s2, 256
    s_cbranch_scc1 L_attn_kernel_end
    s_load_dwordx2 s[4:5], s[0:1], 72
    v_and_b32 v1, 63, v0
    v_lshrrev_b32 v2, 6, v0
    s_and_b32 s3, s2, 7
    s_lshl_b32 s3, s3, 2
    s_lshr_b32 s6, s2, 3
    s_and_b32 s7, s6, 3
    s_add_u32 s3, s3, s7
    s_lshr_b32 s6, s2, 5
    v_readfirstlane_b32 s20, v2
    s_mul_i32 s7, s3, 163840
    s_mul_i32 s21, s3, 81920
    s_waitcnt lgkmcnt(0)
    s_add_u32 s8, s4, 2621440
    s_addc_u32 s9, s5, 0
    s_add_u32 s8, s8, s7
    s_addc_u32 s9, s9, 0
    s_mov_b32 s10, 163840
    s_mov_b32 s11, 0x20000
    s_add_u32 s12, s4, s21
    s_addc_u32 s13, s5, 0
    s_mov_b32 s14, 81920
    s_mov_b32 s15, 0x20000
    s_add_u32 s16, s4, 14942208
    s_addc_u32 s17, s5, 0
    s_mov_b32 s18, 2621440
    s_mov_b32 s19, 0x20000
    s_cmp_ge_u32 s20, 8
    s_cbranch_scc1 L_attn_kernel_prod
    s_setprio 2
    s_and_b32 s24, s20, 3
    s_lshr_b32 s25, s20, 2
    s_lshl_b32 s22, s6, 3
    s_lshl_b32 s24, s24, 1
    s_add_u32 s22, s22, s24
    s_mul_i32 s23, s22, 1280
    s_add_u32 s22, s22, s25
    v_lshlrev_b32 v3, 4, v1
    v_and_b32 v2, 31, v1
    v_lshlrev_b32 v112, 3, v2
    v_add_u32 v112, 1024, v112
    v_mov_b32 v8, 0
    v_mov_b32 v9, 0
    v_mov_b32 v148, 0
    v_mov_b32 v149, 0
    s_mov_b32 s40, -1
    s_mov_b32 s41, 0
    buffer_load_dwordx4 v[4:7], v3, s[12:15], s23 offen
    buffer_load_dwordx4 v[144:147], v3, s[12:15], s23 offen offset:1280
    s_mov_b64 exec, s[40:41]
    buffer_load_dwordx2 v[8:9], v112, s[12:15], s23 offen
    buffer_load_dwordx2 v[148:149], v112, s[12:15], s23 offen offset:1280
    s_mov_b64 exec, -1
    s_mul_i32 s26, s25, 10240
    v_add_u32 v104, s26, v3
    v_add_u32 v105, s26, v112
    v_lshrrev_b32 v113, 5, v1
    v_mul_u32_u24 v115, 320, v113
    v_lshlrev_b32 v114, 4, v2
    v_add_u32 v106, v115, v114
    v_add_u32 v109, 1280, v106
    v_add_u32 v106, s26, v109
    v_mul_u32_u24 v115, 20, v113
    v_add_u32 v115, v115, v2
    v_and_b32 v115, 15, v115
    v_lshlrev_b32 v115, 4, v115
    v_add_u32 v115, 81920, v115
    v_add_u32 v116, 256, v115
    v_cmp_eq_u32 vcc, 20, v2
    s_nop 1
    v_cndmask_b32 v115, v115, v116, vcc
    v_cmp_gt_u32 vcc, 20, v2
    s_nop 1
    v_cndmask_b32 v106, v115, v106, vcc
    v_mov_b32 v116, 0
    v_mov_b32 v117, 2560
    v_cndmask_b32 v107, v116, v117, vcc
    v_mov_b32 v117, 1
    v_cndmask_b32 v108, v116, v117, vcc
    v_lshlrev_b32 v118, 4, v1
    v_add_u32 v118, 81920, v118
    v_mov_b32 v120, 0x3f803f80
    v_lshrrev_b32 v119, 4, v1
    v_cmp_eq_u32 vcc, 1, v119
    s_nop 1
    v_cndmask_b32 v120, v116, v120, vcc
    v_mov_b32 v121, v120
    v_mov_b32 v122, v120
    v_mov_b32 v123, v120
    ds_write_b128 v118, v[120:123]
    ds_write_b128 v118, v[120:123] offset:640
    v_mov_b32 v88, 0
    v_mov_b32 v92, 0
    v_mov_b32 v89, 0
    v_mov_b32 v93, 0
    v_mov_b32 v90, 0
    v_mov_b32 v94, 0
    v_mov_b32 v91, 0
    v_mov_b32 v95, 0
    v_mov_b32 v96, 0
    v_mov_b32 v100, 0
    v_mov_b32 v97, 0
    v_mov_b32 v101, 0
    v_mov_b32 v98, 0
    v_mov_b32 v102, 0
    v_mov_b32 v99, 0
    v_mov_b32 v103, 0
    v_mov_b32 v44, 0
    v_mov_b32 v128, 0
    v_mov_b32 v28, 0
    v_mov_b32 v45, 0
    v_mov_b32 v129, 0
    v_mov_b32 v29, 0
    v_mov_b32 v46, 0
    v_mov_b32 v130, 0
    v_mov_b32 v30, 0
    v_mov_b32 v47, 0
    v_mov_b32 v131, 0
    v_mov_b32 v31, 0
    v_mov_b32 v48, 0
    v_mov_b32 v132, 0
    v_mov_b32 v32, 0
    v_mov_b32 v49, 0
    v_mov_b32 v133, 0
    v_mov_b32 v33, 0
    v_mov_b32 v50, 0
    v_mov_b32 v134, 0
    v_mov_b32 v34, 0
    v_mov_b32 v51, 0
    v_mov_b32 v135, 0
    v_mov_b32 v35, 0
    v_mov_b32 v52, 0
    v_mov_b32 v136, 0
    v_mov_b32 v36, 0
    v_mov_b32 v53, 0
    v_mov_b32 v137, 0
    v_mov_b32 v37, 0
    v_mov_b32 v54, 0
    v_mov_b32 v138, 0
    v_mov_b32 v38, 0
    v_mov_b32 v55, 0
    v_mov_b32 v139, 0
    v_mov_b32 v39, 0
    v_mov_b32 v56, 0
    v_mov_b32 v140, 0
    v_mov_b32 v40, 0
    v_mov_b32 v57, 0
    v_mov_b32 v141, 0
    v_mov_b32 v41, 0
    v_mov_b32 v58, 0
    v_mov_b32 v142, 0
    v_mov_b32 v42, 0
    v_mov_b32 v59, 0
    v_mov_b32 v143, 0
    v_mov_b32 v43, 0
    v_mov_b32 v68, 0
    v_mov_b32 v69, 0
    v_mov_b32 v70, 0
    v_mov_b32 v71, 0
    v_mov_b32 v72, 0
    v_mov_b32 v73, 0
    v_mov_b32 v74, 0
    v_mov_b32 v75, 0
    s_mov_b32 s26, 0
    s_mov_b32 s31, 0
    s_waitcnt vmcnt(0) lgkmcnt(0)
    s_barrier
    ds_read_b128 v[76:79], v104
    ds_read_b64 v[80:81], v105
    ds_read_b128 v[82:85], v104 offset:2560
    ds_read_b64 v[86:87], v105 offset:2560
    s_waitcnt lgkmcnt(0)
    v_mfma_f32_32x32x16_bf16 v[12:27], v[76:79], v[4:7], 0
    v_mfma_f32_32x32x8_bf16 v[12:27], v[80:81], v[8:9], v[12:27]
    s_nop 15
L_attn_kernel_loop:
    s_waitcnt lgkmcnt(0)
    v_mfma_f32_32x32x16_bf16 v[128:143], v[96:99], v[68:71], v[128:143]
    v_exp_f32 v12, v12
    ds_read_b128 v[88:91], v106
    v_exp_f32 v13, v13
    ds_read_b128 v[92:95], v106 offset:640
    v_cvt_pk_bf16_f32 v75, v42, v43
    v_exp_f32 v14, v14
    v_add_u32 v106, v107, v106
    v_exp_f32 v15, v15
    v_cvt_pk_bf16_f32 v60, v12, v13
    v_mfma_f32_32x32x16_bf16 v[28:43], v[76:79], v[144:147], 0
    v_exp_f32 v16, v16
    v_exp_f32 v17, v17
    v_cvt_pk_bf16_f32 v61, v14, v15
    v_exp_f32 v18, v18
    v_exp_f32 v19, v19
    v_cvt_pk_bf16_f32 v62, v16, v17
    v_mfma_f32_32x32x8_bf16 v[28:43], v[80:81], v[148:149], v[28:43]
    v_exp_f32 v20, v20
    v_exp_f32 v21, v21
    v_cvt_pk_bf16_f32 v63, v18, v19
    v_exp_f32 v22, v22
    v_exp_f32 v23, v23
    v_cvt_pk_bf16_f32 v64, v20, v21
    v_mfma_f32_32x32x16_bf16 v[128:143], v[100:103], v[72:75], v[128:143]
    v_exp_f32 v24, v24
    v_exp_f32 v25, v25
    v_cvt_pk_bf16_f32 v65, v22, v23
    v_exp_f32 v26, v26
    v_exp_f32 v27, v27
    v_cvt_pk_bf16_f32 v66, v24, v25
    s_waitcnt lgkmcnt(0)
    v_mfma_f32_32x32x16_bf16 v[44:59], v[88:91], v[60:63], v[44:59]
    v_exp_f32 v28, v28
    ds_read_b128 v[76:79], v104 offset:5120
    v_exp_f32 v29, v29
    ds_read_b64 v[80:81], v105 offset:5120
    v_cvt_pk_bf16_f32 v67, v26, v27
    v_exp_f32 v30, v30
    v_exp_f32 v31, v31
    v_cvt_pk_bf16_f32 v68, v28, v29
    v_mfma_f32_32x32x16_bf16 v[12:27], v[82:85], v[4:7], 0
    v_exp_f32 v32, v32
    v_exp_f32 v33, v33
    v_cvt_pk_bf16_f32 v69, v30, v31
    v_exp_f32 v34, v34
    v_exp_f32 v35, v35
    v_cvt_pk_bf16_f32 v70, v32, v33
    v_mfma_f32_32x32x8_bf16 v[12:27], v[86:87], v[8:9], v[12:27]
    v_exp_f32 v36, v36
    v_exp_f32 v37, v37
    v_cvt_pk_bf16_f32 v71, v34, v35
    v_exp_f32 v38, v38
    v_exp_f32 v39, v39
    v_cvt_pk_bf16_f32 v72, v36, v37
    v_mfma_f32_32x32x16_bf16 v[44:59], v[92:95], v[64:67], v[44:59]
    v_exp_f32 v40, v40
    v_exp_f32 v41, v41
    v_cvt_pk_bf16_f32 v73, v38, v39
    v_exp_f32 v42, v42
    v_exp_f32 v43, v43
    v_cvt_pk_bf16_f32 v74, v40, v41
    s_waitcnt lgkmcnt(0)
    v_mfma_f32_32x32x16_bf16 v[128:143], v[88:91], v[68:71], v[128:143]
    v_exp_f32 v12, v12
    ds_read_b128 v[96:99], v106
    v_exp_f32 v13, v13
    ds_read_b128 v[100:103], v106 offset:640
    v_cvt_pk_bf16_f32 v75, v42, v43
    v_exp_f32 v14, v14
    v_add_u32 v106, v107, v106
    v_exp_f32 v15, v15
    v_cvt_pk_bf16_f32 v60, v12, v13
    v_mfma_f32_32x32x16_bf16 v[28:43], v[82:85], v[144:147], 0
    v_exp_f32 v16, v16
    v_exp_f32 v17, v17
    v_cvt_pk_bf16_f32 v61, v14, v15
    v_exp_f32 v18, v18
    v_exp_f32 v19, v19
    v_cvt_pk_bf16_f32 v62, v16, v17
    v_mfma_f32_32x32x8_bf16 v[28:43], v[86:87], v[148:149], v[28:43]
    v_exp_f32 v20, v20
    v_exp_f32 v21, v21
    v_cvt_pk_bf16_f32 v63, v18, v19
    v_exp_f32 v22, v22
    v_exp_f32 v23, v23
    v_cvt_pk_bf16_f32 v64, v20, v21
    v_mfma_f32_32x32x16_bf16 v[128:143], v[92:95], v[72:75], v[128:143]
    v_exp_f32 v24, v24
    v_exp_f32 v25, v25
    v_cvt_pk_bf16_f32 v65, v22, v23
    v_exp_f32 v26, v26
    v_exp_f32 v27, v27
    v_cvt_pk_bf16_f32 v66, v24, v25
    s_waitcnt lgkmcnt(0)
    v_mfma_f32_32x32x16_bf16 v[44:59], v[96:99], v[60:63], v[44:59]
    v_exp_f32 v28, v28
    ds_read_b128 v[82:85], v104 offset:7680
    v_exp_f32 v29, v29
    ds_read_b64 v[86:87], v105 offset:7680
    v_cvt_pk_bf16_f32 v67, v26, v27
    v_exp_f32 v30, v30
    v_exp_f32 v31, v31
    v_cvt_pk_bf16_f32 v68, v28, v29
    v_mfma_f32_32x32x16_bf16 v[12:27], v[76:79], v[4:7], 0
    v_exp_f32 v32, v32
    v_exp_f32 v33, v33
    v_cvt_pk_bf16_f32 v69, v30, v31
    v_exp_f32 v34, v34
    v_exp_f32 v35, v35
    v_cvt_pk_bf16_f32 v70, v32, v33
    v_mfma_f32_32x32x8_bf16 v[12:27], v[80:81], v[8:9], v[12:27]
    v_exp_f32 v36, v36
    v_exp_f32 v37, v37
    v_cvt_pk_bf16_f32 v71, v34, v35
    v_exp_f32 v38, v38
    v_exp_f32 v39, v39
    v_cvt_pk_bf16_f32 v72, v36, v37
    v_mfma_f32_32x32x16_bf16 v[44:59], v[100:103], v[64:67], v[44:59]
    v_exp_f32 v40, v40
    v_exp_f32 v41, v41
    v_cvt_pk_bf16_f32 v73, v38, v39
    v_exp_f32 v42, v42
    v_exp_f32 v43, v43
    v_cvt_pk_bf16_f32 v74, v40, v41
    s_waitcnt lgkmcnt(0)
    v_mfma_f32_32x32x16_bf16 v[128:143], v[96:99], v[68:71], v[128:143]
    v_exp_f32 v12, v12
    ds_read_b128 v[88:91], v106
    v_exp_f32 v13, v13
    ds_read_b128 v[92:95], v106 offset:640
    v_cvt_pk_bf16_f32 v75, v42, v43
    v_exp_f32 v14, v14
    v_add_u32 v106, v107, v106
    v_exp_f32 v15, v15
    v_cvt_pk_bf16_f32 v60, v12, v13
    v_mfma_f32_32x32x16_bf16 v[28:43], v[76:79], v[144:147], 0
    v_exp_f32 v16, v16
    v_exp_f32 v17, v17
    v_cvt_pk_bf16_f32 v61, v14, v15
    v_exp_f32 v18, v18
    v_exp_f32 v19, v19
    v_cvt_pk_bf16_f32 v62, v16, v17
    v_mfma_f32_32x32x8_bf16 v[28:43], v[80:81], v[148:149], v[28:43]
    v_exp_f32 v20, v20
    v_exp_f32 v21, v21
    v_cvt_pk_bf16_f32 v63, v18, v19
    v_exp_f32 v22, v22
    v_exp_f32 v23, v23
    v_cvt_pk_bf16_f32 v64, v20, v21
    v_mfma_f32_32x32x16_bf16 v[128:143], v[100:103], v[72:75], v[128:143]
    v_exp_f32 v24, v24
    v_exp_f32 v25, v25
    v_cvt_pk_bf16_f32 v65, v22, v23
    v_exp_f32 v26, v26
    v_exp_f32 v27, v27
    v_cvt_pk_bf16_f32 v66, v24, v25
    s_waitcnt lgkmcnt(0)
    v_mfma_f32_32x32x16_bf16 v[44:59], v[88:91], v[60:63], v[44:59]
    v_exp_f32 v28, v28
    s_barrier
    v_exp_f32 v29, v29
    s_add_u32 s31, s31, 1
    v_cvt_pk_bf16_f32 v67, v26, v27
    v_exp_f32 v30, v30
    s_and_b32 s31, s31, 3
    v_exp_f32 v31, v31
    s_mov_b32 s29, 20480
    v_cvt_pk_bf16_f32 v68, v28, v29
    v_mfma_f32_32x32x16_bf16 v[12:27], v[82:85], v[4:7], 0
    v_exp_f32 v32, v32
    s_cmp_eq_u32 s31, 0
    v_exp_f32 v33, v33
    s_cselect_b32 s29, 4294905856, s29
    v_cvt_pk_bf16_f32 v69, v30, v31
    v_exp_f32 v34, v34
    v_add_u32 v104, s29, v104
    v_exp_f32 v35, v35
    v_add_u32 v105, s29, v105
    v_cvt_pk_bf16_f32 v70, v32, v33
    v_mfma_f32_32x32x8_bf16 v[12:27], v[86:87], v[8:9], v[12:27]
    v_exp_f32 v36, v36
    ds_read_b128 v[76:79], v104 offset:0
    v_exp_f32 v37, v37
    ds_read_b64 v[80:81], v105 offset:0
    v_cvt_pk_bf16_f32 v71, v34, v35
    v_exp_f32 v38, v38
    v_exp_f32 v39, v39
    v_cvt_pk_bf16_f32 v72, v36, v37
    v_mfma_f32_32x32x16_bf16 v[44:59], v[92:95], v[64:67], v[44:59]
    v_exp_f32 v40, v40
    v_exp_f32 v41, v41
    v_cvt_pk_bf16_f32 v73, v38, v39
    v_exp_f32 v42, v42
    v_exp_f32 v43, v43
    v_cvt_pk_bf16_f32 v74, v40, v41
    s_waitcnt lgkmcnt(0)
    v_mfma_f32_32x32x16_bf16 v[128:143], v[88:91], v[68:71], v[128:143]
    v_exp_f32 v12, v12
    ds_read_b128 v[96:99], v106
    v_exp_f32 v13, v13
    ds_read_b128 v[100:103], v106 offset:640
    v_cvt_pk_bf16_f32 v75, v42, v43
    v_exp_f32 v14, v14
    s_sub_u32 s30, s29, 7680
    v_exp_f32 v15, v15
    v_mul_lo_u32 v124, s30, v108
    v_cvt_pk_bf16_f32 v60, v12, v13
    v_mfma_f32_32x32x16_bf16 v[28:43], v[82:85], v[144:147], 0
    v_exp_f32 v16, v16
    v_add_u32 v106, v124, v106
    v_exp_f32 v17, v17
    v_cvt_pk_bf16_f32 v61, v14, v15
    v_exp_f32 v18, v18
    v_exp_f32 v19, v19
    v_cvt_pk_bf16_f32 v62, v16, v17
    v_mfma_f32_32x32x8_bf16 v[28:43], v[86:87], v[148:149], v[28:43]
    v_exp_f32 v20, v20
    v_exp_f32 v21, v21
    v_cvt_pk_bf16_f32 v63, v18, v19
    v_exp_f32 v22, v22
    v_exp_f32 v23, v23
    v_cvt_pk_bf16_f32 v64, v20, v21
    v_mfma_f32_32x32x16_bf16 v[128:143], v[92:95], v[72:75], v[128:143]
    v_exp_f32 v24, v24
    v_exp_f32 v25, v25
    v_cvt_pk_bf16_f32 v65, v22, v23
    v_exp_f32 v26, v26
    v_exp_f32 v27, v27
    v_cvt_pk_bf16_f32 v66, v24, v25
    s_waitcnt lgkmcnt(0)
    v_mfma_f32_32x32x16_bf16 v[44:59], v[96:99], v[60:63], v[44:59]
    v_exp_f32 v28, v28
    ds_read_b128 v[82:85], v104 offset:2560
    v_exp_f32 v29, v29
    ds_read_b64 v[86:87], v105 offset:2560
    v_cvt_pk_bf16_f32 v67, v26, v27
    v_exp_f32 v30, v30
    s_add_u32 s26, s26, 1
    v_exp_f32 v31, v31
    v_cvt_pk_bf16_f32 v68, v28, v29
    v_mfma_f32_32x32x16_bf16 v[12:27], v[76:79], v[4:7], 0
    v_exp_f32 v32, v32
    v_exp_f32 v33, v33
    v_cvt_pk_bf16_f32 v69, v30, v31
    v_exp_f32 v34, v34
    v_exp_f32 v35, v35
    v_cvt_pk_bf16_f32 v70, v32, v33
    v_mfma_f32_32x32x8_bf16 v[12:27], v[80:81], v[8:9], v[12:27]
    v_exp_f32 v36, v36
    v_exp_f32 v37, v37
    v_cvt_pk_bf16_f32 v71, v34, v35
    v_exp_f32 v38, v38
    v_exp_f32 v39, v39
    v_cvt_pk_bf16_f32 v72, v36, v37
    v_mfma_f32_32x32x16_bf16 v[44:59], v[100:103], v[64:67], v[44:59]
    v_exp_f32 v40, v40
    v_exp_f32 v41, v41
    v_cvt_pk_bf16_f32 v73, v38, v39
    v_exp_f32 v42, v42
    v_exp_f32 v43, v43
    v_cvt_pk_bf16_f32 v74, v40, v41
    s_cmp_lt_u32 s26, 8
    s_cbranch_scc1 L_attn_kernel_loop
    s_waitcnt lgkmcnt(0)
    v_cvt_pk_bf16_f32 v75, v42, v43
    s_nop 1
    v_mfma_f32_32x32x16_bf16 v[128:143], v[96:99], v[68:71], v[128:143]
    v_mfma_f32_32x32x16_bf16 v[128:143], v[100:103], v[72:75], v[128:143]
    s_nop 15
    s_nop 3
    s_cmp_eq_u32 s25, 0
    s_cbranch_scc1 L_attn_kernel_nosw
    v_swap_b32 v44, v128
    v_swap_b32 v45, v129
    v_swap_b32 v46, v130
    v_swap_b32 v47, v131
    v_swap_b32 v48, v132
    v_swap_b32 v49, v133
    v_swap_b32 v50, v134
    v_swap_b32 v51, v135
    v_swap_b32 v52, v136
    v_swap_b32 v53, v137
    v_swap_b32 v54, v138
    v_swap_b32 v55, v139
    v_mov_b32 v4, v144
    v_mov_b32 v5, v145
    v_mov_b32 v6, v146
    v_mov_b32 v7, v147
    v_mov_b32 v8, v148
    v_mov_b32 v9, v149
L_attn_kernel_nosw:
    s_mul_i32 s33, s20, 3072
    s_add_u32 s33, s33, 83200
    v_add_u32 v112, s33, v3
    s_xor_b32 s34, s20, 4
    s_mul_i32 s34, s34, 3072
    s_add_u32 s34, s34, 83200
    v_add_u32 v113, s34, v3
    ds_write_b128 v112, v[128:131] offset:0
    ds_write_b128 v112, v[132:135] offset:1024
    ds_write_b128 v112, v[136:139] offset:2048
    s_waitcnt lgkmcnt(0)
    s_barrier
    ds_read_b128 v[12:15], v113 offset:0
    ds_read_b128 v[16:19], v113 offset:1024
    ds_read_b128 v[20:23], v113 offset:2048
    s_waitcnt lgkmcnt(0)
    v_add_f32 v44, v44, v12
    v_add_f32 v45, v45, v13
    v_add_f32 v46, v46, v14
    v_add_f32 v47, v47, v15
    v_add_f32 v48, v48, v16
    v_add_f32 v49, v49, v17
    v_add_f32 v50, v50, v18
    v_add_f32 v51, v51, v19
    v_add_f32 v52, v52, v20
    v_add_f32 v53, v53, v21
    v_add_f32 v54, v54, v22
    v_add_f32 v55, v55, v23
    v_mov_b32 v112, v52
    v_mov_b32 v113, v52
    v_mul_f32 v115, 0, v44
    v_fma_f32 v115, v45, 0, v115
    v_fma_f32 v115, v46, 0, v115
    v_fma_f32 v115, v47, 0, v115
    v_fma_f32 v115, v48, 0, v115
    v_fma_f32 v115, v49, 0, v115
    v_fma_f32 v115, v50, 0, v115
    v_fma_f32 v115, v51, 0, v115
    v_fma_f32 v115, v52, 0, v115
    v_fma_f32 v115, v53, 0, v115
    v_fma_f32 v115, v54, 0, v115
    v_fma_f32 v115, v55, 0, v115
    v_permlane32_swap_b32 v112, v113
    s_mov_b32 s36, 562036736
    s_mov_b32 s37, 1568669696
    v_cmp_o_f32 s[42:43], v115, v115
    v_cmp_le_f32 vcc, s36, v113
    s_nop 1
    s_and_b64 s[42:43], s[42:43], vcc
    v_cmp_ge_f32 vcc, s37, v113
    s_nop 1
    s_and_b64 s[42:43], s[42:43], vcc
    s_cmp_eq_u64 s[42:43], -1
    s_cbranch_scc0 L_attn_kernel_fb
L_attn_kernel_epi:
    v_rcp_f32 v114, v113
    s_nop 0
    v_mul_f32 v44, v44, v114
    v_mul_f32 v45, v45, v114
    v_mul_f32 v46, v46, v114
    v_mul_f32 v47, v47, v114
    v_mul_f32 v48, v48, v114
    v_mul_f32 v49, v49, v114
    v_mul_f32 v50, v50, v114
    v_mul_f32 v51, v51, v114
    v_mul_f32 v52, v52, v114
    v_mul_f32 v53, v53, v114
    v_mul_f32 v54, v54, v114
    v_mul_f32 v55, v55, v114
    v_cvt_pk_bf16_f32 v116, v44, v45
    v_cvt_pk_bf16_f32 v117, v46, v47
    v_cvt_pk_bf16_f32 v118, v48, v49
    v_cvt_pk_bf16_f32 v119, v50, v51
    v_cvt_pk_bf16_f32 v120, v52, v53
    v_cvt_pk_bf16_f32 v121, v54, v55
    s_mul_i32 s33, s22, 40960
    s_lshl_b32 s34, s3, 10
    s_add_u32 s34, s34, s33
    buffer_store_dwordx4 v[116:119], v3, s[16:19], s34 offen
    s_lshr_b32 s35, s3, 2
    s_add_u32 s35, s35, 32
    s_lshl_b32 s35, s35, 10
    s_add_u32 s35, s35, s33
    s_and_b32 s36, s3, 2
    s_lshl_b32 s36, s36, 8
    s_add_u32 s35, s35, s36
    s_and_b32 s36, s3, 1
    s_lshl_b32 s36, s36, 3
    s_add_u32 s35, s35, s36
    s_mov_b64 exec, s[40:41]
    buffer_store_dwordx2 v[120:121], v3, s[16:19], s35 offen
    s_mov_b64 exec, -1
    s_endpgm
L_attn_kernel_fb:
    v_lshlrev_b32 v105, 3, v2
    v_add_u32 v105, 1024, v105
    v_mov_b32 v124, 0xff800000
    v_mov_b32 v116, 0x3f803f80
    v_mov_b32 v117, 0
    v_cmp_eq_u32 vcc, 20, v2
    s_nop 1
    v_cndmask_b32 v116, v117, v116, vcc
    v_cmp_gt_u32 s[44:45], 20, v2
    s_mov_b32 s26, 0
    v_mov_b32 v88, v116
    v_mov_b32 v92, v116
    v_mov_b32 v89, v116
    v_mov_b32 v93, v116
    v_mov_b32 v90, v116
    v_mov_b32 v94, v116
    v_mov_b32 v91, v116
    v_mov_b32 v95, v116
L_attn_kernel_fb1:
    buffer_load_dwordx4 v[76:79], v3, s[8:11], s26 offen
    buffer_load_dwordx2 v[80:81], v105, s[8:11], s26 offen
    s_waitcnt vmcnt(0)
    v_mfma_f32_32x32x16_bf16 v[12:27], v[76:79], v[4:7], 0
    v_mfma_f32_32x32x8_bf16 v[12:27], v[80:81], v[8:9], v[12:27]
    s_nop 15
    s_nop 15
    v_max_f32 v124, v124, v12
    v_max_f32 v124, v124, v13
    v_max_f32 v124, v124, v14
    v_max_f32 v124, v124, v15
    v_max_f32 v124, v124, v16
    v_max_f32 v124, v124, v17
    v_max_f32 v124, v124, v18
    v_max_f32 v124, v124, v19
    v_max_f32 v124, v124, v20
    v_max_f32 v124, v124, v21
    v_max_f32 v124, v124, v22
    v_max_f32 v124, v124, v23
    v_max_f32 v124, v124, v24
    v_max_f32 v124, v124, v25
    v_max_f32 v124, v124, v26
    v_max_f32 v124, v124, v27
    s_add_u32 s26, s26, 2560
    s_cmp_lt_u32 s26, 163840
    s_cbranch_scc1 L_attn_kernel_fb1
    v_mov_b32 v112, v124
    v_mov_b32 v113, v124
    s_nop 1
    v_permlane32_swap_b32 v112, v113
    s_nop 1
    v_max_f32 v124, v112, v113
    s_mov_b32 s26, 0
    v_mov_b32 v44, 0
    v_mov_b32 v45, 0
    v_mov_b32 v46, 0
    v_mov_b32 v47, 0
    v_mov_b32 v48, 0
    v_mov_b32 v49, 0
    v_mov_b32 v50, 0
    v_mov_b32 v51, 0
    v_mov_b32 v52, 0
    v_mov_b32 v53, 0
    v_mov_b32 v54, 0
    v_mov_b32 v55, 0
    v_mov_b32 v56, 0
    v_mov_b32 v57, 0
    v_mov_b32 v58, 0
    v_mov_b32 v59, 0
L_attn_kernel_fb2:
    buffer_load_dwordx4 v[76:79], v3, s[8:11], s26 offen
    buffer_load_dwordx2 v[80:81], v105, s[8:11], s26 offen
    s_mov_b64 exec, s[44:45]
    buffer_load_dwordx4 v[88:91], v109, s[8:11], s26 offen
    buffer_load_dwordx4 v[92:95], v109, s[8:11], s26 offen offset:640
    s_mov_b64 exec, -1
    s_waitcnt vmcnt(0)
    v_mfma_f32_32x32x16_bf16 v[12:27], v[76:79], v[4:7], 0
    v_mfma_f32_32x32x8_bf16 v[12:27], v[80:81], v[8:9], v[12:27]
    s_nop 15
    s_nop 15
    v_sub_f32 v12, v12, v124
    v_sub_f32 v13, v13, v124
    v_sub_f32 v14, v14, v124
    v_sub_f32 v15, v15, v124
    v_sub_f32 v16, v16, v124
    v_sub_f32 v17, v17, v124
    v_sub_f32 v18, v18, v124
    v_sub_f32 v19, v19, v124
    v_sub_f32 v20, v20, v124
    v_sub_f32 v21, v21, v124
    v_sub_f32 v22, v22, v124
    v_sub_f32 v23, v23, v124
    v_sub_f32 v24, v24, v124
    v_sub_f32 v25, v25, v124
    v_sub_f32 v26, v26, v124
    v_sub_f32 v27, v27, v124
    v_exp_f32 v12, v12
    v_exp_f32 v13, v13
    v_exp_f32 v14, v14
    v_exp_f32 v15, v15
    v_exp_f32 v16, v16
    v_exp_f32 v17, v17
    v_exp_f32 v18, v18
    v_exp_f32 v19, v19
    v_exp_f32 v20, v20
    v_exp_f32 v21, v21
    v_exp_f32 v22, v22
    v_exp_f32 v23, v23
    v_exp_f32 v24, v24
    v_exp_f32 v25, v25
    v_exp_f32 v26, v26
    v_exp_f32 v27, v27
    s_nop 1
    v_cvt_pk_bf16_f32 v60, v12, v13
    v_cvt_pk_bf16_f32 v61, v14, v15
    v_cvt_pk_bf16_f32 v62, v16, v17
    v_cvt_pk_bf16_f32 v63, v18, v19
    v_cvt_pk_bf16_f32 v64, v20, v21
    v_cvt_pk_bf16_f32 v65, v22, v23
    v_cvt_pk_bf16_f32 v66, v24, v25
    v_cvt_pk_bf16_f32 v67, v26, v27
    s_nop 1
    v_mfma_f32_32x32x16_bf16 v[44:59], v[88:91], v[60:63], v[44:59]
    v_mfma_f32_32x32x16_bf16 v[44:59], v[92:95], v[64:67], v[44:59]
    s_nop 15
    s_nop 15
    s_add_u32 s26, s26, 2560
    s_cmp_lt_u32 s26, 163840
    s_cbranch_scc1 L_attn_kernel_fb2
    v_mov_b32 v112, v52
    v_mov_b32 v113, v52
    s_nop 1
    v_permlane32_swap_b32 v112, v113
    s_nop 1
    s_branch L_attn_kernel_epi
L_attn_kernel_prod:
    s_sub_u32 s21, s20, 8
    v_lshlrev_b32 v2, 4, v1
    s_mul_i32 s24, s21, 5120
    s_and_b32 s22, s21, 1
    s_mul_i32 s22, s22, 5120
    s_lshr_b32 s23, s21, 1
    s_mul_i32 s23, s23, 81920
    s_add_u32 s22, s22, s23
    s_add_u32 m0, s24, 0
    s_add_u32 s25, s22, 0
    buffer_load_dwordx4 v2, s[8:11], s25 offen offset:0 lds
    buffer_load_dwordx4 v2, s[8:11], s25 offen offset:1024 lds
    buffer_load_dwordx4 v2, s[8:11], s25 offen offset:2048 lds
    buffer_load_dwordx4 v2, s[8:11], s25 offen offset:3072 lds
    s_add_u32 m0, s24, 4096
    s_add_u32 s25, s22, 4096
    buffer_load_dwordx4 v2, s[8:11], s25 offen lds
    s_and_b32 s26, s2, 7
    s_lshr_b32 s27, s2, 3
    s_lshr_b32 s28, s26, 1
    s_lshl_b32 s28, s28, 4
    s_lshr_b32 s29, s27, 1
    s_add_u32 s28, s28, s29
    s_and_b32 s29, s26, 1
    s_lshl_b32 s29, s29, 1
    s_and_b32 s30, s27, 1
    s_add_u32 s29, s29, s30
    s_add_u32 s60, s4, 7864320
    s_addc_u32 s61, s5, 0
    s_mov_b32 s62, 7077888
    s_mov_b32 s63, 0x20000
    s_add_u32 s64, s4, 17563648
    s_addc_u32 s65, s5, 0
    s_mov_b32 s66, 3031040
    s_mov_b32 s67, 0x20000
    s_add_u32 s68, s4, 20594688
    s_addc_u32 s69, s5, 0
    s_mov_b32 s70, 2621440
    s_mov_b32 s71, 0x20000
    s_lshl_b32 s31, s21, 10
    s_mul_i32 s48, s28, 110592
    s_add_u32 s48, s48, s31
    s_mul_i32 s50, s29, 757760
    s_add_u32 s50, s50, s31
    s_add_u32 s51, s50, 151552
    s_add_u32 s52, s50, 303104
    s_add_u32 s53, s50, 454656
    s_add_u32 s54, s50, 606208
    s_add_u32 m0, s24, 20480
    s_add_u32 s25, s22, 10240
    buffer_load_dwordx4 v2, s[8:11], s25 offen offset:0 lds
    buffer_load_dwordx4 v2, s[8:11], s25 offen offset:1024 lds
    buffer_load_dwordx4 v2, s[8:11], s25 offen offset:2048 lds
    buffer_load_dwordx4 v2, s[8:11], s25 offen offset:3072 lds
    s_add_u32 m0, s24, 24576
    s_add_u32 s25, s22, 14336
    buffer_load_dwordx4 v2, s[8:11], s25 offen lds
    s_waitcnt vmcnt(5)
    s_barrier
    s_add_u32 m0, s24, 40960
    s_add_u32 s25, s22, 20480
    buffer_load_dwordx4 v2, s[8:11], s25 offen offset:0 lds
    buffer_load_dwordx4 v2, s[8:11], s25 offen offset:1024 lds
    buffer_load_dwordx4 v2, s[8:11], s25 offen offset:2048 lds
    buffer_load_dwordx4 v2, s[8:11], s25 offen offset:3072 lds
    s_add_u32 m0, s24, 45056
    s_add_u32 s25, s22, 24576
    buffer_load_dwordx4 v2, s[8:11], s25 offen lds
    buffer_load_dwordx4 v[88:91], v2, s[60:63], s48 offen
    buffer_load_dwordx4 v[92:95], v2, s[64:67], s50 offen
    buffer_load_dwordx4 v[96:99], v2, s[64:67], s51 offen
    buffer_load_dwordx4 v[100:103], v2, s[64:67], s52 offen
    buffer_load_dwordx4 v[104:107], v2, s[64:67], s53 offen
    buffer_load_dwordx4 v[108:111], v2, s[64:67], s54 offen
    s_add_u32 s48, s48, 4096
    s_add_u32 s50, s50, 4096
    s_add_u32 s51, s51, 4096
    s_add_u32 s52, s52, 4096
    s_add_u32 s53, s53, 4096
    s_add_u32 s54, s54, 4096
    buffer_load_dwordx4 v[112:115], v2, s[60:63], s48 offen
    buffer_load_dwordx4 v[116:119], v2, s[64:67], s50 offen
    buffer_load_dwordx4 v[120:123], v2, s[64:67], s51 offen
    buffer_load_dwordx4 v[124:127], v2, s[64:67], s52 offen
    buffer_load_dwordx4 v[128:131], v2, s[64:67], s53 offen
    buffer_load_dwordx4 v[132:135], v2, s[64:67], s54 offen
    s_add_u32 s48, s48, 4096
    s_add_u32 s50, s50, 4096
    s_add_u32 s51, s51, 4096
    s_add_u32 s52, s52, 4096
    s_add_u32 s53, s53, 4096
    s_add_u32 s54, s54, 4096
    buffer_load_dwordx4 v[136:139], v2, s[60:63], s48 offen
    buffer_load_dwordx4 v[140:143], v2, s[64:67], s50 offen
    buffer_load_dwordx4 v[144:147], v2, s[64:67], s51 offen
    buffer_load_dwordx4 v[148:151], v2, s[64:67], s52 offen
    buffer_load_dwordx4 v[152:155], v2, s[64:67], s53 offen
    buffer_load_dwordx4 v[156:159], v2, s[64:67], s54 offen
    s_add_u32 s48, s48, 4096
    s_add_u32 s50, s50, 4096
    s_add_u32 s51, s51, 4096
    s_add_u32 s52, s52, 4096
    s_add_u32 s53, s53, 4096
    s_add_u32 s54, s54, 4096
    v_mov_b32 v8, 0
    v_mov_b32 v9, 0
    v_mov_b32 v10, 0
    v_mov_b32 v11, 0
    v_mov_b32 v12, 0
    v_mov_b32 v13, 0
    v_mov_b32 v14, 0
    v_mov_b32 v15, 0
    v_mov_b32 v16, 0
    v_mov_b32 v17, 0
    v_mov_b32 v18, 0
    v_mov_b32 v19, 0
    v_mov_b32 v20, 0
    v_mov_b32 v21, 0
    v_mov_b32 v22, 0
    v_mov_b32 v23, 0
    v_mov_b32 v24, 0
    v_mov_b32 v25, 0
    v_mov_b32 v26, 0
    v_mov_b32 v27, 0
    v_mov_b32 v28, 0
    v_mov_b32 v29, 0
    v_mov_b32 v30, 0
    v_mov_b32 v31, 0
    v_mov_b32 v32, 0
    v_mov_b32 v33, 0
    v_mov_b32 v34, 0
    v_mov_b32 v35, 0
    v_mov_b32 v36, 0
    v_mov_b32 v37, 0
    v_mov_b32 v38, 0
    v_mov_b32 v39, 0
    v_mov_b32 v40, 0
    v_mov_b32 v41, 0
    v_mov_b32 v42, 0
    v_mov_b32 v43, 0
    v_mov_b32 v44, 0
    v_mov_b32 v45, 0
    v_mov_b32 v46, 0
    v_mov_b32 v47, 0
    v_mov_b32 v48, 0
    v_mov_b32 v49, 0
    v_mov_b32 v50, 0
    v_mov_b32 v51, 0
    v_mov_b32 v52, 0
    v_mov_b32 v53, 0
    v_mov_b32 v54, 0
    v_mov_b32 v55, 0
    v_mov_b32 v56, 0
    v_mov_b32 v57, 0
    v_mov_b32 v58, 0
    v_mov_b32 v59, 0
    v_mov_b32 v60, 0
    v_mov_b32 v61, 0
    v_mov_b32 v62, 0
    v_mov_b32 v63, 0
    v_mov_b32 v64, 0
    v_mov_b32 v65, 0
    v_mov_b32 v66, 0
    v_mov_b32 v67, 0
    v_mov_b32 v68, 0
    v_mov_b32 v69, 0
    v_mov_b32 v70, 0
    v_mov_b32 v71, 0
    v_mov_b32 v72, 0
    v_mov_b32 v73, 0
    v_mov_b32 v74, 0
    v_mov_b32 v75, 0
    v_mov_b32 v76, 0
    v_mov_b32 v77, 0
    v_mov_b32 v78, 0
    v_mov_b32 v79, 0
    v_mov_b32 v80, 0
    v_mov_b32 v81, 0
    v_mov_b32 v82, 0
    v_mov_b32 v83, 0
    v_mov_b32 v84, 0
    v_mov_b32 v85, 0
    v_mov_b32 v86, 0
    v_mov_b32 v87, 0
    s_waitcnt vmcnt(12)
    v_mfma_f32_32x32x16_bf16 v[8:23], v[92:95], v[88:91], v[8:23]
    v_mfma_f32_32x32x16_bf16 v[24:39], v[96:99], v[88:91], v[24:39]
    v_mfma_f32_32x32x16_bf16 v[40:55], v[100:103], v[88:91], v[40:55]
    v_mfma_f32_32x32x16_bf16 v[56:71], v[104:107], v[88:91], v[56:71]
    v_mfma_f32_32x32x16_bf16 v[72:87], v[108:111], v[88:91], v[72:87]
    buffer_load_dwordx4 v[88:91], v2, s[60:63], s48 offen
    buffer_load_dwordx4 v[92:95], v2, s[64:67], s50 offen
    buffer_load_dwordx4 v[96:99], v2, s[64:67], s51 offen
    buffer_load_dwordx4 v[100:103], v2, s[64:67], s52 offen
    buffer_load_dwordx4 v[104:107], v2, s[64:67], s53 offen
    buffer_load_dwordx4 v[108:111], v2, s[64:67], s54 offen
    s_add_u32 s48, s48, 4096
    s_add_u32 s50, s50, 4096
    s_add_u32 s51, s51, 4096
    s_add_u32 s52, s52, 4096
    s_add_u32 s53, s53, 4096
    s_add_u32 s54, s54, 4096
    s_waitcnt vmcnt(12)
    v_mfma_f32_32x32x16_bf16 v[8:23], v[116:119], v[112:115], v[8:23]
    v_mfma_f32_32x32x16_bf16 v[24:39], v[120:123], v[112:115], v[24:39]
    v_mfma_f32_32x32x16_bf16 v[40:55], v[124:127], v[112:115], v[40:55]
    v_mfma_f32_32x32x16_bf16 v[56:71], v[128:131], v[112:115], v[56:71]
    v_mfma_f32_32x32x16_bf16 v[72:87], v[132:135], v[112:115], v[72:87]
    buffer_load_dwordx4 v[112:115], v2, s[60:63], s48 offen
    buffer_load_dwordx4 v[116:119], v2, s[64:67], s50 offen
    buffer_load_dwordx4 v[120:123], v2, s[64:67], s51 offen
    buffer_load_dwordx4 v[124:127], v2, s[64:67], s52 offen
    buffer_load_dwordx4 v[128:131], v2, s[64:67], s53 offen
    buffer_load_dwordx4 v[132:135], v2, s[64:67], s54 offen
    s_add_u32 s48, s48, 4096
    s_add_u32 s50, s50, 4096
    s_add_u32 s51, s51, 4096
    s_add_u32 s52, s52, 4096
    s_add_u32 s53, s53, 4096
    s_add_u32 s54, s54, 4096
    s_waitcnt vmcnt(12)
    v_mfma_f32_32x32x16_bf16 v[8:23], v[140:143], v[136:139], v[8:23]
    v_mfma_f32_32x32x16_bf16 v[24:39], v[144:147], v[136:139], v[24:39]
    v_mfma_f32_32x32x16_bf16 v[40:55], v[148:151], v[136:139], v[40:55]
    v_mfma_f32_32x32x16_bf16 v[56:71], v[152:155], v[136:139], v[56:71]
    v_mfma_f32_32x32x16_bf16 v[72:87], v[156:159], v[136:139], v[72:87]
    buffer_load_dwordx4 v[136:139], v2, s[60:63], s48 offen
    buffer_load_dwordx4 v[140:143], v2, s[64:67], s50 offen
    buffer_load_dwordx4 v[144:147], v2, s[64:67], s51 offen
    buffer_load_dwordx4 v[148:151], v2, s[64:67], s52 offen
    buffer_load_dwordx4 v[152:155], v2, s[64:67], s53 offen
    buffer_load_dwordx4 v[156:159], v2, s[64:67], s54 offen
    s_add_u32 s48, s48, 4096
    s_add_u32 s50, s50, 4096
    s_add_u32 s51, s51, 4096
    s_add_u32 s52, s52, 4096
    s_add_u32 s53, s53, 4096
    s_add_u32 s54, s54, 4096
    s_waitcnt vmcnt(12)
    v_mfma_f32_32x32x16_bf16 v[8:23], v[92:95], v[88:91], v[8:23]
    v_mfma_f32_32x32x16_bf16 v[24:39], v[96:99], v[88:91], v[24:39]
    v_mfma_f32_32x32x16_bf16 v[40:55], v[100:103], v[88:91], v[40:55]
    v_mfma_f32_32x32x16_bf16 v[56:71], v[104:107], v[88:91], v[56:71]
    v_mfma_f32_32x32x16_bf16 v[72:87], v[108:111], v[88:91], v[72:87]
    buffer_load_dwordx4 v[88:91], v2, s[60:63], s48 offen
    buffer_load_dwordx4 v[92:95], v2, s[64:67], s50 offen
    buffer_load_dwordx4 v[96:99], v2, s[64:67], s51 offen
    buffer_load_dwordx4 v[100:103], v2, s[64:67], s52 offen
    buffer_load_dwordx4 v[104:107], v2, s[64:67], s53 offen
    buffer_load_dwordx4 v[108:111], v2, s[64:67], s54 offen
    s_add_u32 s48, s48, 4096
    s_add_u32 s50, s50, 4096
    s_add_u32 s51, s51, 4096
    s_add_u32 s52, s52, 4096
    s_add_u32 s53, s53, 4096
    s_add_u32 s54, s54, 4096
    s_barrier
    s_add_u32 m0, s24, 61440
    s_add_u32 s25, s22, 30720
    buffer_load_dwordx4 v2, s[8:11], s25 offen offset:0 lds
    buffer_load_dwordx4 v2, s[8:11], s25 offen offset:1024 lds
    buffer_load_dwordx4 v2, s[8:11], s25 offen offset:2048 lds
    buffer_load_dwordx4 v2, s[8:11], s25 offen offset:3072 lds
    s_add_u32 m0, s24, 65536
    s_add_u32 s25, s22, 34816
    buffer_load_dwordx4 v2, s[8:11], s25 offen lds
    s_waitcnt vmcnt(17)
    v_mfma_f32_32x32x16_bf16 v[8:23], v[116:119], v[112:115], v[8:23]
    v_mfma_f32_32x32x16_bf16 v[24:39], v[120:123], v[112:115], v[24:39]
    v_mfma_f32_32x32x16_bf16 v[40:55], v[124:127], v[112:115], v[40:55]
    v_mfma_f32_32x32x16_bf16 v[56:71], v[128:131], v[112:115], v[56:71]
    v_mfma_f32_32x32x16_bf16 v[72:87], v[132:135], v[112:115], v[72:87]
    buffer_load_dwordx4 v[112:115], v2, s[60:63], s48 offen
    buffer_load_dwordx4 v[116:119], v2, s[64:67], s50 offen
    buffer_load_dwordx4 v[120:123], v2, s[64:67], s51 offen
    buffer_load_dwordx4 v[124:127], v2, s[64:67], s52 offen
    buffer_load_dwordx4 v[128:131], v2, s[64:67], s53 offen
    buffer_load_dwordx4 v[132:135], v2, s[64:67], s54 offen
    s_add_u32 s48, s48, 4096
    s_add_u32 s50, s50, 4096
    s_add_u32 s51, s51, 4096
    s_add_u32 s52, s52, 4096
    s_add_u32 s53, s53, 4096
    s_add_u32 s54, s54, 4096
    s_waitcnt vmcnt(17)
    v_mfma_f32_32x32x16_bf16 v[8:23], v[140:143], v[136:139], v[8:23]
    v_mfma_f32_32x32x16_bf16 v[24:39], v[144:147], v[136:139], v[24:39]
    v_mfma_f32_32x32x16_bf16 v[40:55], v[148:151], v[136:139], v[40:55]
    v_mfma_f32_32x32x16_bf16 v[56:71], v[152:155], v[136:139], v[56:71]
    v_mfma_f32_32x32x16_bf16 v[72:87], v[156:159], v[136:139], v[72:87]
    buffer_load_dwordx4 v[136:139], v2, s[60:63], s48 offen
    buffer_load_dwordx4 v[140:143], v2, s[64:67], s50 offen
    buffer_load_dwordx4 v[144:147], v2, s[64:67], s51 offen
    buffer_load_dwordx4 v[148:151], v2, s[64:67], s52 offen
    buffer_load_dwordx4 v[152:155], v2, s[64:67], s53 offen
    buffer_load_dwordx4 v[156:159], v2, s[64:67], s54 offen
    s_add_u32 s48, s48, 4096
    s_add_u32 s50, s50, 4096
    s_add_u32 s51, s51, 4096
    s_add_u32 s52, s52, 4096
    s_add_u32 s53, s53, 4096
    s_add_u32 s54, s54, 4096
    s_waitcnt vmcnt(17)
    v_mfma_f32_32x32x16_bf16 v[8:23], v[92:95], v[88:91], v[8:23]
    v_mfma_f32_32x32x16_bf16 v[24:39], v[96:99], v[88:91], v[24:39]
    v_mfma_f32_32x32x16_bf16 v[40:55], v[100:103], v[88:91], v[40:55]
    v_mfma_f32_32x32x16_bf16 v[56:71], v[104:107], v[88:91], v[56:71]
    v_mfma_f32_32x32x16_bf16 v[72:87], v[108:111], v[88:91], v[72:87]
    buffer_load_dwordx4 v[88:91], v2, s[60:63], s48 offen
    buffer_load_dwordx4 v[92:95], v2, s[64:67], s50 offen
    buffer_load_dwordx4 v[96:99], v2, s[64:67], s51 offen
    buffer_load_dwordx4 v[100:103], v2, s[64:67], s52 offen
    buffer_load_dwordx4 v[104:107], v2, s[64:67], s53 offen
    buffer_load_dwordx4 v[108:111], v2, s[64:67], s54 offen
    s_add_u32 s48, s48, 4096
    s_add_u32 s50, s50, 4096
    s_add_u32 s51, s51, 4096
    s_add_u32 s52, s52, 4096
    s_add_u32 s53, s53, 4096
    s_add_u32 s54, s54, 4096
    s_waitcnt vmcnt(12)
    v_mfma_f32_32x32x16_bf16 v[8:23], v[116:119], v[112:115], v[8:23]
    v_mfma_f32_32x32x16_bf16 v[24:39], v[120:123], v[112:115], v[24:39]
    v_mfma_f32_32x32x16_bf16 v[40:55], v[124:127], v[112:115], v[40:55]
    v_mfma_f32_32x32x16_bf16 v[56:71], v[128:131], v[112:115], v[56:71]
    v_mfma_f32_32x32x16_bf16 v[72:87], v[132:135], v[112:115], v[72:87]
    buffer_load_dwordx4 v[112:115], v2, s[60:63], s48 offen
    buffer_load_dwordx4 v[116:119], v2, s[64:67], s50 offen
    buffer_load_dwordx4 v[120:123], v2, s[64:67], s51 offen
    buffer_load_dwordx4 v[124:127], v2, s[64:67], s52 offen
    buffer_load_dwordx4 v[128:131], v2, s[64:67], s53 offen
    buffer_load_dwordx4 v[132:135], v2, s[64:67], s54 offen
    s_add_u32 s48, s48, 4096
    s_add_u32 s50, s50, 4096
    s_add_u32 s51, s51, 4096
    s_add_u32 s52, s52, 4096
    s_add_u32 s53, s53, 4096
    s_add_u32 s54, s54, 4096
    s_barrier
    s_add_u32 m0, s24, 0
    s_add_u32 s25, s22, 40960
    buffer_load_dwordx4 v2, s[8:11], s25 offen offset:0 lds
    buffer_load_dwordx4 v2, s[8:11], s25 offen offset:1024 lds
    buffer_load_dwordx4 v2, s[8:11], s25 offen offset:2048 lds
    buffer_load_dwordx4 v2, s[8:11], s25 offen offset:3072 lds
    s_add_u32 m0, s24, 4096
    s_add_u32 s25, s22, 45056
    buffer_load_dwordx4 v2, s[8:11], s25 offen lds
    s_waitcnt vmcnt(17)
    v_mfma_f32_32x32x16_bf16 v[8:23], v[140:143], v[136:139], v[8:23]
    v_mfma_f32_32x32x16_bf16 v[24:39], v[144:147], v[136:139], v[24:39]
    v_mfma_f32_32x32x16_bf16 v[40:55], v[148:151], v[136:139], v[40:55]
    v_mfma_f32_32x32x16_bf16 v[56:71], v[152:155], v[136:139], v[56:71]
    v_mfma_f32_32x32x16_bf16 v[72:87], v[156:159], v[136:139], v[72:87]
    buffer_load_dwordx4 v[136:139], v2, s[60:63], s48 offen
    buffer_load_dwordx4 v[140:143], v2, s[64:67], s50 offen
    buffer_load_dwordx4 v[144:147], v2, s[64:67], s51 offen
    buffer_load_dwordx4 v[148:151], v2, s[64:67], s52 offen
    buffer_load_dwordx4 v[152:155], v2, s[64:67], s53 offen
    buffer_load_dwordx4 v[156:159], v2, s[64:67], s54 offen
    s_add_u32 s48, s48, 4096
    s_add_u32 s50, s50, 4096
    s_add_u32 s51, s51, 4096
    s_add_u32 s52, s52, 4096
    s_add_u32 s53, s53, 4096
    s_add_u32 s54, s54, 4096
    s_waitcnt vmcnt(17)
    v_mfma_f32_32x32x16_bf16 v[8:23], v[92:95], v[88:91], v[8:23]
    v_mfma_f32_32x32x16_bf16 v[24:39], v[96:99], v[88:91], v[24:39]
    v_mfma_f32_32x32x16_bf16 v[40:55], v[100:103], v[88:91], v[40:55]
    v_mfma_f32_32x32x16_bf16 v[56:71], v[104:107], v[88:91], v[56:71]
    v_mfma_f32_32x32x16_bf16 v[72:87], v[108:111], v[88:91], v[72:87]
    buffer_load_dwordx4 v[88:91], v2, s[60:63], s48 offen
    buffer_load_dwordx4 v[92:95], v2, s[64:67], s50 offen
    buffer_load_dwordx4 v[96:99], v2, s[64:67], s51 offen
    buffer_load_dwordx4 v[100:103], v2, s[64:67], s52 offen
    buffer_load_dwordx4 v[104:107], v2, s[64:67], s53 offen
    buffer_load_dwordx4 v[108:111], v2, s[64:67], s54 offen
    s_add_u32 s48, s48, 4096
    s_add_u32 s50, s50, 4096
    s_add_u32 s51, s51, 4096
    s_add_u32 s52, s52, 4096
    s_add_u32 s53, s53, 4096
    s_add_u32 s54, s54, 4096
    s_waitcnt vmcnt(17)
    v_mfma_f32_32x32x16_bf16 v[8:23], v[116:119], v[112:115], v[8:23]
    v_mfma_f32_32x32x16_bf16 v[24:39], v[120:123], v[112:115], v[24:39]
    v_mfma_f32_32x32x16_bf16 v[40:55], v[124:127], v[112:115], v[40:55]
    v_mfma_f32_32x32x16_bf16 v[56:71], v[128:131], v[112:115], v[56:71]
    v_mfma_f32_32x32x16_bf16 v[72:87], v[132:135], v[112:115], v[72:87]
    buffer_load_dwordx4 v[112:115], v2, s[60:63], s48 offen
    buffer_load_dwordx4 v[116:119], v2, s[64:67], s50 offen
    buffer_load_dwordx4 v[120:123], v2, s[64:67], s51 offen
    buffer_load_dwordx4 v[124:127], v2, s[64:67], s52 offen
    buffer_load_dwordx4 v[128:131], v2, s[64:67], s53 offen
    buffer_load_dwordx4 v[132:135], v2, s[64:67], s54 offen
    s_add_u32 s48, s48, 4096
    s_add_u32 s50, s50, 4096
    s_add_u32 s51, s51, 4096
    s_add_u32 s52, s52, 4096
    s_add_u32 s53, s53, 4096
    s_add_u32 s54, s54, 4096
    s_waitcnt vmcnt(12)
    v_mfma_f32_32x32x16_bf16 v[8:23], v[140:143], v[136:139], v[8:23]
    v_mfma_f32_32x32x16_bf16 v[24:39], v[144:147], v[136:139], v[24:39]
    v_mfma_f32_32x32x16_bf16 v[40:55], v[148:151], v[136:139], v[40:55]
    v_mfma_f32_32x32x16_bf16 v[56:71], v[152:155], v[136:139], v[56:71]
    v_mfma_f32_32x32x16_bf16 v[72:87], v[156:159], v[136:139], v[72:87]
    buffer_load_dwordx4 v[136:139], v2, s[60:63], s48 offen
    buffer_load_dwordx4 v[140:143], v2, s[64:67], s50 offen
    buffer_load_dwordx4 v[144:147], v2, s[64:67], s51 offen
    buffer_load_dwordx4 v[148:151], v2, s[64:67], s52 offen
    buffer_load_dwordx4 v[152:155], v2, s[64:67], s53 offen
    buffer_load_dwordx4 v[156:159], v2, s[64:67], s54 offen
    s_add_u32 s48, s48, 4096
    s_add_u32 s50, s50, 4096
    s_add_u32 s51, s51, 4096
    s_add_u32 s52, s52, 4096
    s_add_u32 s53, s53, 4096
    s_add_u32 s54, s54, 4096
    s_barrier
    s_add_u32 m0, s24, 20480
    s_add_u32 s25, s22, 51200
    buffer_load_dwordx4 v2, s[8:11], s25 offen offset:0 lds
    buffer_load_dwordx4 v2, s[8:11], s25 offen offset:1024 lds
    buffer_load_dwordx4 v2, s[8:11], s25 offen offset:2048 lds
    buffer_load_dwordx4 v2, s[8:11], s25 offen offset:3072 lds
    s_add_u32 m0, s24, 24576
    s_add_u32 s25, s22, 55296
    buffer_load_dwordx4 v2, s[8:11], s25 offen lds
    s_waitcnt vmcnt(17)
    v_mfma_f32_32x32x16_bf16 v[8:23], v[92:95], v[88:91], v[8:23]
    v_mfma_f32_32x32x16_bf16 v[24:39], v[96:99], v[88:91], v[24:39]
    v_mfma_f32_32x32x16_bf16 v[40:55], v[100:103], v[88:91], v[40:55]
    v_mfma_f32_32x32x16_bf16 v[56:71], v[104:107], v[88:91], v[56:71]
    v_mfma_f32_32x32x16_bf16 v[72:87], v[108:111], v[88:91], v[72:87]
    buffer_load_dwordx4 v[88:91], v2, s[60:63], s48 offen
    buffer_load_dwordx4 v[92:95], v2, s[64:67], s50 offen
    buffer_load_dwordx4 v[96:99], v2, s[64:67], s51 offen
    buffer_load_dwordx4 v[100:103], v2, s[64:67], s52 offen
    buffer_load_dwordx4 v[104:107], v2, s[64:67], s53 offen
    buffer_load_dwordx4 v[108:111], v2, s[64:67], s54 offen
    s_add_u32 s48, s48, 4096
    s_add_u32 s50, s50, 4096
    s_add_u32 s51, s51, 4096
    s_add_u32 s52, s52, 4096
    s_add_u32 s53, s53, 4096
    s_add_u32 s54, s54, 4096
    s_waitcnt vmcnt(17)
    v_mfma_f32_32x32x16_bf16 v[8:23], v[116:119], v[112:115], v[8:23]
    v_mfma_f32_32x32x16_bf16 v[24:39], v[120:123], v[112:115], v[24:39]
    v_mfma_f32_32x32x16_bf16 v[40:55], v[124:127], v[112:115], v[40:55]
    v_mfma_f32_32x32x16_bf16 v[56:71], v[128:131], v[112:115], v[56:71]
    v_mfma_f32_32x32x16_bf16 v[72:87], v[132:135], v[112:115], v[72:87]
    buffer_load_dwordx4 v[112:115], v2, s[60:63], s48 offen
    buffer_load_dwordx4 v[116:119], v2, s[64:67], s50 offen
    buffer_load_dwordx4 v[120:123], v2, s[64:67], s51 offen
    buffer_load_dwordx4 v[124:127], v2, s[64:67], s52 offen
    buffer_load_dwordx4 v[128:131], v2, s[64:67], s53 offen
    buffer_load_dwordx4 v[132:135], v2, s[64:67], s54 offen
    s_add_u32 s48, s48, 4096
    s_add_u32 s50, s50, 4096
    s_add_u32 s51, s51, 4096
    s_add_u32 s52, s52, 4096
    s_add_u32 s53, s53, 4096
    s_add_u32 s54, s54, 4096
    s_waitcnt vmcnt(17)
    v_mfma_f32_32x32x16_bf16 v[8:23], v[140:143], v[136:139], v[8:23]
    v_mfma_f32_32x32x16_bf16 v[24:39], v[144:147], v[136:139], v[24:39]
    v_mfma_f32_32x32x16_bf16 v[40:55], v[148:151], v[136:139], v[40:55]
    v_mfma_f32_32x32x16_bf16 v[56:71], v[152:155], v[136:139], v[56:71]
    v_mfma_f32_32x32x16_bf16 v[72:87], v[156:159], v[136:139], v[72:87]
    buffer_load_dwordx4 v[136:139], v2, s[60:63], s48 offen
    buffer_load_dwordx4 v[140:143], v2, s[64:67], s50 offen
    buffer_load_dwordx4 v[144:147], v2, s[64:67], s51 offen
    buffer_load_dwordx4 v[148:151], v2, s[64:67], s52 offen
    buffer_load_dwordx4 v[152:155], v2, s[64:67], s53 offen
    buffer_load_dwordx4 v[156:159], v2, s[64:67], s54 offen
    s_add_u32 s48, s48, 4096
    s_add_u32 s50, s50, 4096
    s_add_u32 s51, s51, 4096
    s_add_u32 s52, s52, 4096
    s_add_u32 s53, s53, 4096
    s_add_u32 s54, s54, 4096
    s_waitcnt vmcnt(12)
    v_mfma_f32_32x32x16_bf16 v[8:23], v[92:95], v[88:91], v[8:23]
    v_mfma_f32_32x32x16_bf16 v[24:39], v[96:99], v[88:91], v[24:39]
    v_mfma_f32_32x32x16_bf16 v[40:55], v[100:103], v[88:91], v[40:55]
    v_mfma_f32_32x32x16_bf16 v[56:71], v[104:107], v[88:91], v[56:71]
    v_mfma_f32_32x32x16_bf16 v[72:87], v[108:111], v[88:91], v[72:87]
    buffer_load_dwordx4 v[88:91], v2, s[60:63], s48 offen
    buffer_load_dwordx4 v[92:95], v2, s[64:67], s50 offen
    buffer_load_dwordx4 v[96:99], v2, s[64:67], s51 offen
    buffer_load_dwordx4 v[100:103], v2, s[64:67], s52 offen
    buffer_load_dwordx4 v[104:107], v2, s[64:67], s53 offen
    buffer_load_dwordx4 v[108:111], v2, s[64:67], s54 offen
    s_add_u32 s48, s48, 4096
    s_add_u32 s50, s50, 4096
    s_add_u32 s51, s51, 4096
    s_add_u32 s52, s52, 4096
    s_add_u32 s53, s53, 4096
    s_add_u32 s54, s54, 4096
    s_barrier
    s_add_u32 m0, s24, 40960
    s_add_u32 s25, s22, 61440
    buffer_load_dwordx4 v2, s[8:11], s25 offen offset:0 lds
    buffer_load_dwordx4 v2, s[8:11], s25 offen offset:1024 lds
    buffer_load_dwordx4 v2, s[8:11], s25 offen offset:2048 lds
    buffer_load_dwordx4 v2, s[8:11], s25 offen offset:3072 lds
    s_add_u32 m0, s24, 45056
    s_add_u32 s25, s22, 65536
    buffer_load_dwordx4 v2, s[8:11], s25 offen lds
    s_waitcnt vmcnt(17)
    v_mfma_f32_32x32x16_bf16 v[8:23], v[116:119], v[112:115], v[8:23]
    v_mfma_f32_32x32x16_bf16 v[24:39], v[120:123], v[112:115], v[24:39]
    v_mfma_f32_32x32x16_bf16 v[40:55], v[124:127], v[112:115], v[40:55]
    v_mfma_f32_32x32x16_bf16 v[56:71], v[128:131], v[112:115], v[56:71]
    v_mfma_f32_32x32x16_bf16 v[72:87], v[132:135], v[112:115], v[72:87]
    buffer_load_dwordx4 v[112:115], v2, s[60:63], s48 offen
    buffer_load_dwordx4 v[116:119], v2, s[64:67], s50 offen
    buffer_load_dwordx4 v[120:123], v2, s[64:67], s51 offen
    buffer_load_dwordx4 v[124:127], v2, s[64:67], s52 offen
    buffer_load_dwordx4 v[128:131], v2, s[64:67], s53 offen
    buffer_load_dwordx4 v[132:135], v2, s[64:67], s54 offen
    s_add_u32 s48, s48, 4096
    s_add_u32 s50, s50, 4096
    s_add_u32 s51, s51, 4096
    s_add_u32 s52, s52, 4096
    s_add_u32 s53, s53, 4096
    s_add_u32 s54, s54, 4096
    s_waitcnt vmcnt(17)
    v_mfma_f32_32x32x16_bf16 v[8:23], v[140:143], v[136:139], v[8:23]
    v_mfma_f32_32x32x16_bf16 v[24:39], v[144:147], v[136:139], v[24:39]
    v_mfma_f32_32x32x16_bf16 v[40:55], v[148:151], v[136:139], v[40:55]
    v_mfma_f32_32x32x16_bf16 v[56:71], v[152:155], v[136:139], v[56:71]
    v_mfma_f32_32x32x16_bf16 v[72:87], v[156:159], v[136:139], v[72:87]
    buffer_load_dwordx4 v[136:139], v2, s[60:63], s48 offen
    buffer_load_dwordx4 v[140:143], v2, s[64:67], s50 offen
    buffer_load_dwordx4 v[144:147], v2, s[64:67], s51 offen
    buffer_load_dwordx4 v[148:151], v2, s[64:67], s52 offen
    buffer_load_dwordx4 v[152:155], v2, s[64:67], s53 offen
    buffer_load_dwordx4 v[156:159], v2, s[64:67], s54 offen
    s_add_u32 s48, s48, 4096
    s_add_u32 s50, s50, 4096
    s_add_u32 s51, s51, 4096
    s_add_u32 s52, s52, 4096
    s_add_u32 s53, s53, 4096
    s_add_u32 s54, s54, 4096
    s_waitcnt vmcnt(17)
    v_mfma_f32_32x32x16_bf16 v[8:23], v[92:95], v[88:91], v[8:23]
    v_mfma_f32_32x32x16_bf16 v[24:39], v[96:99], v[88:91], v[24:39]
    v_mfma_f32_32x32x16_bf16 v[40:55], v[100:103], v[88:91], v[40:55]
    v_mfma_f32_32x32x16_bf16 v[56:71], v[104:107], v[88:91], v[56:71]
    v_mfma_f32_32x32x16_bf16 v[72:87], v[108:111], v[88:91], v[72:87]
    buffer_load_dwordx4 v[88:91], v2, s[60:63], s48 offen
    buffer_load_dwordx4 v[92:95], v2, s[64:67], s50 offen
    buffer_load_dwordx4 v[96:99], v2, s[64:67], s51 offen
    buffer_load_dwordx4 v[100:103], v2, s[64:67], s52 offen
    buffer_load_dwordx4 v[104:107], v2, s[64:67], s53 offen
    buffer_load_dwordx4 v[108:111], v2, s[64:67], s54 offen
    s_add_u32 s48, s48, 4096
    s_add_u32 s50, s50, 4096
    s_add_u32 s51, s51, 4096
    s_add_u32 s52, s52, 4096
    s_add_u32 s53, s53, 4096
    s_add_u32 s54, s54, 4096
    s_waitcnt vmcnt(12)
    v_mfma_f32_32x32x16_bf16 v[8:23], v[116:119], v[112:115], v[8:23]
    v_mfma_f32_32x32x16_bf16 v[24:39], v[120:123], v[112:115], v[24:39]
    v_mfma_f32_32x32x16_bf16 v[40:55], v[124:127], v[112:115], v[40:55]
    v_mfma_f32_32x32x16_bf16 v[56:71], v[128:131], v[112:115], v[56:71]
    v_mfma_f32_32x32x16_bf16 v[72:87], v[132:135], v[112:115], v[72:87]
    buffer_load_dwordx4 v[112:115], v2, s[60:63], s48 offen
    buffer_load_dwordx4 v[116:119], v2, s[64:67], s50 offen
    buffer_load_dwordx4 v[120:123], v2, s[64:67], s51 offen
    buffer_load_dwordx4 v[124:127], v2, s[64:67], s52 offen
    buffer_load_dwordx4 v[128:131], v2, s[64:67], s53 offen
    buffer_load_dwordx4 v[132:135], v2, s[64:67], s54 offen
    s_add_u32 s48, s48, 4096
    s_add_u32 s50, s50, 4096
    s_add_u32 s51, s51, 4096
    s_add_u32 s52, s52, 4096
    s_add_u32 s53, s53, 4096
    s_add_u32 s54, s54, 4096
    s_barrier
    s_add_u32 m0, s24, 61440
    s_add_u32 s25, s22, 71680
    buffer_load_dwordx4 v2, s[8:11], s25 offen offset:0 lds
    buffer_load_dwordx4 v2, s[8:11], s25 offen offset:1024 lds
    buffer_load_dwordx4 v2, s[8:11], s25 offen offset:2048 lds
    buffer_load_dwordx4 v2, s[8:11], s25 offen offset:3072 lds
    s_add_u32 m0, s24, 65536
    s_add_u32 s25, s22, 75776
    buffer_load_dwordx4 v2, s[8:11], s25 offen lds
    s_waitcnt vmcnt(17)
    v_mfma_f32_32x32x16_bf16 v[8:23], v[140:143], v[136:139], v[8:23]
    v_mfma_f32_32x32x16_bf16 v[24:39], v[144:147], v[136:139], v[24:39]
    v_mfma_f32_32x32x16_bf16 v[40:55], v[148:151], v[136:139], v[40:55]
    v_mfma_f32_32x32x16_bf16 v[56:71], v[152:155], v[136:139], v[56:71]
    v_mfma_f32_32x32x16_bf16 v[72:87], v[156:159], v[136:139], v[72:87]
    buffer_load_dwordx4 v[136:139], v2, s[60:63], s48 offen
    buffer_load_dwordx4 v[140:143], v2, s[64:67], s50 offen
    buffer_load_dwordx4 v[144:147], v2, s[64:67], s51 offen
    buffer_load_dwordx4 v[148:151], v2, s[64:67], s52 offen
    buffer_load_dwordx4 v[152:155], v2, s[64:67], s53 offen
    buffer_load_dwordx4 v[156:159], v2, s[64:67], s54 offen
    s_add_u32 s48, s48, 4096
    s_add_u32 s50, s50, 4096
    s_add_u32 s51, s51, 4096
    s_add_u32 s52, s52, 4096
    s_add_u32 s53, s53, 4096
    s_add_u32 s54, s54, 4096
    s_waitcnt vmcnt(17)
    v_mfma_f32_32x32x16_bf16 v[8:23], v[92:95], v[88:91], v[8:23]
    v_mfma_f32_32x32x16_bf16 v[24:39], v[96:99], v[88:91], v[24:39]
    v_mfma_f32_32x32x16_bf16 v[40:55], v[100:103], v[88:91], v[40:55]
    v_mfma_f32_32x32x16_bf16 v[56:71], v[104:107], v[88:91], v[56:71]
    v_mfma_f32_32x32x16_bf16 v[72:87], v[108:111], v[88:91], v[72:87]
    buffer_load_dwordx4 v[88:91], v2, s[60:63], s48 offen
    buffer_load_dwordx4 v[92:95], v2, s[64:67], s50 offen
    buffer_load_dwordx4 v[96:99], v2, s[64:67], s51 offen
    buffer_load_dwordx4 v[100:103], v2, s[64:67], s52 offen
    buffer_load_dwordx4 v[104:107], v2, s[64:67], s53 offen
    buffer_load_dwordx4 v[108:111], v2, s[64:67], s54 offen
    s_add_u32 s48, s48, 4096
    s_add_u32 s50, s50, 4096
    s_add_u32 s51, s51, 4096
    s_add_u32 s52, s52, 4096
    s_add_u32 s53, s53, 4096
    s_add_u32 s54, s54, 4096
    s_waitcnt vmcnt(17)
    v_mfma_f32_32x32x16_bf16 v[8:23], v[116:119], v[112:115], v[8:23]
    v_mfma_f32_32x32x16_bf16 v[24:39], v[120:123], v[112:115], v[24:39]
    v_mfma_f32_32x32x16_bf16 v[40:55], v[124:127], v[112:115], v[40:55]
    v_mfma_f32_32x32x16_bf16 v[56:71], v[128:131], v[112:115], v[56:71]
    v_mfma_f32_32x32x16_bf16 v[72:87], v[132:135], v[112:115], v[72:87]
    buffer_load_dwordx4 v[112:115], v2, s[60:63], s48 offen
    buffer_load_dwordx4 v[116:119], v2, s[64:67], s50 offen
    buffer_load_dwordx4 v[120:123], v2, s[64:67], s51 offen
    buffer_load_dwordx4 v[124:127], v2, s[64:67], s52 offen
    buffer_load_dwordx4 v[128:131], v2, s[64:67], s53 offen
    buffer_load_dwordx4 v[132:135], v2, s[64:67], s54 offen
    s_add_u32 s48, s48, 4096
    s_add_u32 s50, s50, 4096
    s_add_u32 s51, s51, 4096
    s_add_u32 s52, s52, 4096
    s_add_u32 s53, s53, 4096
    s_add_u32 s54, s54, 4096
    s_waitcnt vmcnt(12)
    v_mfma_f32_32x32x16_bf16 v[8:23], v[140:143], v[136:139], v[8:23]
    v_mfma_f32_32x32x16_bf16 v[24:39], v[144:147], v[136:139], v[24:39]
    v_mfma_f32_32x32x16_bf16 v[40:55], v[148:151], v[136:139], v[40:55]
    v_mfma_f32_32x32x16_bf16 v[56:71], v[152:155], v[136:139], v[56:71]
    v_mfma_f32_32x32x16_bf16 v[72:87], v[156:159], v[136:139], v[72:87]
    buffer_load_dwordx4 v[136:139], v2, s[60:63], s48 offen
    buffer_load_dwordx4 v[140:143], v2, s[64:67], s50 offen
    buffer_load_dwordx4 v[144:147], v2, s[64:67], s51 offen
    buffer_load_dwordx4 v[148:151], v2, s[64:67], s52 offen
    buffer_load_dwordx4 v[152:155], v2, s[64:67], s53 offen
    buffer_load_dwordx4 v[156:159], v2, s[64:67], s54 offen
    s_add_u32 s48, s48, 4096
    s_add_u32 s50, s50, 4096
    s_add_u32 s51, s51, 4096
    s_add_u32 s52, s52, 4096
    s_add_u32 s53, s53, 4096
    s_add_u32 s54, s54, 4096
    s_barrier
    s_waitcnt vmcnt(12)
    v_mfma_f32_32x32x16_bf16 v[8:23], v[92:95], v[88:91], v[8:23]
    v_mfma_f32_32x32x16_bf16 v[24:39], v[96:99], v[88:91], v[24:39]
    v_mfma_f32_32x32x16_bf16 v[40:55], v[100:103], v[88:91], v[40:55]
    v_mfma_f32_32x32x16_bf16 v[56:71], v[104:107], v[88:91], v[56:71]
    v_mfma_f32_32x32x16_bf16 v[72:87], v[108:111], v[88:91], v[72:87]
    s_waitcnt vmcnt(6)
    v_mfma_f32_32x32x16_bf16 v[8:23], v[116:119], v[112:115], v[8:23]
    v_mfma_f32_32x32x16_bf16 v[24:39], v[120:123], v[112:115], v[24:39]
    v_mfma_f32_32x32x16_bf16 v[40:55], v[124:127], v[112:115], v[40:55]
    v_mfma_f32_32x32x16_bf16 v[56:71], v[128:131], v[112:115], v[56:71]
    v_mfma_f32_32x32x16_bf16 v[72:87], v[132:135], v[112:115], v[72:87]
    s_waitcnt vmcnt(0)
    v_mfma_f32_32x32x16_bf16 v[8:23], v[140:143], v[136:139], v[8:23]
    v_mfma_f32_32x32x16_bf16 v[24:39], v[144:147], v[136:139], v[24:39]
    v_mfma_f32_32x32x16_bf16 v[40:55], v[148:151], v[136:139], v[40:55]
    v_mfma_f32_32x32x16_bf16 v[56:71], v[152:155], v[136:139], v[56:71]
    v_mfma_f32_32x32x16_bf16 v[72:87], v[156:159], v[136:139], v[72:87]
    s_mul_i32 s33, s21, 15360
    s_add_u32 s33, s33, 83200
    v_add_u32 v3, s33, v2
    s_cmp_lg_u32 s21, 0
    s_cbranch_scc1 L_attn_kernel_w0
    s_nop 7
    s_nop 7
    ds_write_b128 v3, v[12:15] offset:0
    ds_write_b128 v3, v[16:19] offset:1024
    ds_write_b128 v3, v[20:23] offset:2048
    ds_write_b128 v3, v[28:31] offset:3072
    ds_write_b128 v3, v[32:35] offset:4096
    ds_write_b128 v3, v[36:39] offset:5120
    ds_write_b128 v3, v[44:47] offset:6144
    ds_write_b128 v3, v[48:51] offset:7168
    ds_write_b128 v3, v[52:55] offset:8192
    ds_write_b128 v3, v[60:63] offset:9216
    ds_write_b128 v3, v[64:67] offset:10240
    ds_write_b128 v3, v[68:71] offset:11264
    ds_write_b128 v3, v[76:79] offset:12288
    ds_write_b128 v3, v[80:83] offset:13312
    ds_write_b128 v3, v[84:87] offset:14336
    v_mov_b32 v88, v8
    v_mov_b32 v89, v9
    v_mov_b32 v90, v10
    v_mov_b32 v91, v11
    v_mov_b32 v92, v24
    v_mov_b32 v93, v25
    v_mov_b32 v94, v26
    v_mov_b32 v95, v27
    v_mov_b32 v96, v40
    v_mov_b32 v97, v41
    v_mov_b32 v98, v42
    v_mov_b32 v99, v43
    v_mov_b32 v100, v56
    v_mov_b32 v101, v57
    v_mov_b32 v102, v58
    v_mov_b32 v103, v59
    v_mov_b32 v104, v72
    v_mov_b32 v105, v73
    v_mov_b32 v106, v74
    v_mov_b32 v107, v75
L_attn_kernel_w0:
    s_cmp_lg_u32 s21, 1
    s_cbranch_scc1 L_attn_kernel_w1
    s_nop 7
    s_nop 7
    ds_write_b128 v3, v[16:19] offset:0
    ds_write_b128 v3, v[20:23] offset:1024
    ds_write_b128 v3, v[8:11] offset:2048
    ds_write_b128 v3, v[32:35] offset:3072
    ds_write_b128 v3, v[36:39] offset:4096
    ds_write_b128 v3, v[24:27] offset:5120
    ds_write_b128 v3, v[48:51] offset:6144
    ds_write_b128 v3, v[52:55] offset:7168
    ds_write_b128 v3, v[40:43] offset:8192
    ds_write_b128 v3, v[64:67] offset:9216
    ds_write_b128 v3, v[68:71] offset:10240
    ds_write_b128 v3, v[56:59] offset:11264
    ds_write_b128 v3, v[80:83] offset:12288
    ds_write_b128 v3, v[84:87] offset:13312
    ds_write_b128 v3, v[72:75] offset:14336
    v_mov_b32 v88, v12
    v_mov_b32 v89, v13
    v_mov_b32 v90, v14
    v_mov_b32 v91, v15
    v_mov_b32 v92, v28
    v_mov_b32 v93, v29
    v_mov_b32 v94, v30
    v_mov_b32 v95, v31
    v_mov_b32 v96, v44
    v_mov_b32 v97, v45
    v_mov_b32 v98, v46
    v_mov_b32 v99, v47
    v_mov_b32 v100, v60
    v_mov_b32 v101, v61
    v_mov_b32 v102, v62
    v_mov_b32 v103, v63
    v_mov_b32 v104, v76
    v_mov_b32 v105, v77
    v_mov_b32 v106, v78
    v_mov_b32 v107, v79
L_attn_kernel_w1:
    s_cmp_lg_u32 s21, 2
    s_cbranch_scc1 L_attn_kernel_w2
    s_nop 7
    s_nop 7
    ds_write_b128 v3, v[20:23] offset:0
    ds_write_b128 v3, v[8:11] offset:1024
    ds_write_b128 v3, v[12:15] offset:2048
    ds_write_b128 v3, v[36:39] offset:3072
    ds_write_b128 v3, v[24:27] offset:4096
    ds_write_b128 v3, v[28:31] offset:5120
    ds_write_b128 v3, v[52:55] offset:6144
    ds_write_b128 v3, v[40:43] offset:7168
    ds_write_b128 v3, v[44:47] offset:8192
    ds_write_b128 v3, v[68:71] offset:9216
    ds_write_b128 v3, v[56:59] offset:10240
    ds_write_b128 v3, v[60:63] offset:11264
    ds_write_b128 v3, v[84:87] offset:12288
    ds_write_b128 v3, v[72:75] offset:13312
    ds_write_b128 v3, v[76:79] offset:14336
    v_mov_b32 v88, v16
    v_mov_b32 v89, v17
    v_mov_b32 v90, v18
    v_mov_b32 v91, v19
    v_mov_b32 v92, v32
    v_mov_b32 v93, v33
    v_mov_b32 v94, v34
    v_mov_b32 v95, v35
    v_mov_b32 v96, v48
    v_mov_b32 v97, v49
    v_mov_b32 v98, v50
    v_mov_b32 v99, v51
    v_mov_b32 v100, v64
    v_mov_b32 v101, v65
    v_mov_b32 v102, v66
    v_mov_b32 v103, v67
    v_mov_b32 v104, v80
    v_mov_b32 v105, v81
    v_mov_b32 v106, v82
    v_mov_b32 v107, v83
L_attn_kernel_w2:
    s_cmp_lg_u32 s21, 3
    s_cbranch_scc1 L_attn_kernel_w3
    s_nop 7
    s_nop 7
    ds_write_b128 v3, v[8:11] offset:0
    ds_write_b128 v3, v[12:15] offset:1024
    ds_write_b128 v3, v[16:19] offset:2048
    ds_write_b128 v3, v[24:27] offset:3072
    ds_write_b128 v3, v[28:31] offset:4096
    ds_write_b128 v3, v[32:35] offset:5120
    ds_write_b128 v3, v[40:43] offset:6144
    ds_write_b128 v3, v[44:47] offset:7168
    ds_write_b128 v3, v[48:51] offset:8192
    ds_write_b128 v3, v[56:59] offset:9216
    ds_write_b128 v3, v[60:63] offset:10240
    ds_write_b128 v3, v[64:67] offset:11264
    ds_write_b128 v3, v[72:75] offset:12288
    ds_write_b128 v3, v[76:79] offset:13312
    ds_write_b128 v3, v[80:83] offset:14336
    v_mov_b32 v88, v20
    v_mov_b32 v89, v21
    v_mov_b32 v90, v22
    v_mov_b32 v91, v23
    v_mov_b32 v92, v36
    v_mov_b32 v93, v37
    v_mov_b32 v94, v38
    v_mov_b32 v95, v39
    v_mov_b32 v96, v52
    v_mov_b32 v97, v53
    v_mov_b32 v98, v54
    v_mov_b32 v99, v55
    v_mov_b32 v100, v68
    v_mov_b32 v101, v69
    v_mov_b32 v102, v70
    v_mov_b32 v103, v71
    v_mov_b32 v104, v84
    v_mov_b32 v105, v85
    v_mov_b32 v106, v86
    v_mov_b32 v107, v87
L_attn_kernel_w3:
    s_waitcnt lgkmcnt(0)
    s_barrier
    v_mov_b32 v3, 0
    s_sub_u32 s33, s21, 1
    s_and_b32 s33, s33, 3
    s_mul_i32 s33, s33, 15360
    s_add_u32 s33, s33, 83200
    v_add_u32 v4, s33, v2
    s_sub_u32 s33, s21, 2
    s_and_b32 s33, s33, 3
    s_mul_i32 s33, s33, 15360
    s_add_u32 s33, s33, 84224
    v_add_u32 v5, s33, v2
    s_sub_u32 s33, s21, 3
    s_and_b32 s33, s33, 3
    s_mul_i32 s33, s33, 15360
    s_add_u32 s33, s33, 85248
    v_add_u32 v6, s33, v2
    ds_read_b128 v[8:11], v4 offset:0
    ds_read_b128 v[12:15], v4 offset:3072
    ds_read_b128 v[16:19], v4 offset:6144
    ds_read_b128 v[20:23], v4 offset:9216
    ds_read_b128 v[24:27], v4 offset:12288
    ds_read_b128 v[28:31], v5 offset:0
    ds_read_b128 v[32:35], v5 offset:3072
    ds_read_b128 v[36:39], v5 offset:6144
    ds_read_b128 v[40:43], v5 offset:9216
    ds_read_b128 v[44:47], v5 offset:12288
    ds_read_b128 v[48:51], v6 offset:0
    ds_read_b128 v[52:55], v6 offset:3072
    ds_read_b128 v[56:59], v6 offset:6144
    ds_read_b128 v[60:63], v6 offset:9216
    ds_read_b128 v[64:67], v6 offset:12288
    s_waitcnt lgkmcnt(0)
    v_add_f32 v88, v88, v8
    v_add_f32 v89, v89, v9
    v_add_f32 v90, v90, v10
    v_add_f32 v91, v91, v11
    v_add_f32 v92, v92, v12
    v_add_f32 v93, v93, v13
    v_add_f32 v94, v94, v14
    v_add_f32 v95, v95, v15
    v_add_f32 v96, v96, v16
    v_add_f32 v97, v97, v17
    v_add_f32 v98, v98, v18
    v_add_f32 v99, v99, v19
    v_add_f32 v100, v100, v20
    v_add_f32 v101, v101, v21
    v_add_f32 v102, v102, v22
    v_add_f32 v103, v103, v23
    v_add_f32 v104, v104, v24
    v_add_f32 v105, v105, v25
    v_add_f32 v106, v106, v26
    v_add_f32 v107, v107, v27
    v_add_f32 v88, v88, v28
    v_add_f32 v89, v89, v29
    v_add_f32 v90, v90, v30
    v_add_f32 v91, v91, v31
    v_add_f32 v92, v92, v32
    v_add_f32 v93, v93, v33
    v_add_f32 v94, v94, v34
    v_add_f32 v95, v95, v35
    v_add_f32 v96, v96, v36
    v_add_f32 v97, v97, v37
    v_add_f32 v98, v98, v38
    v_add_f32 v99, v99, v39
    v_add_f32 v100, v100, v40
    v_add_f32 v101, v101, v41
    v_add_f32 v102, v102, v42
    v_add_f32 v103, v103, v43
    v_add_f32 v104, v104, v44
    v_add_f32 v105, v105, v45
    v_add_f32 v106, v106, v46
    v_add_f32 v107, v107, v47
    v_add_f32 v88, v88, v48
    v_add_f32 v89, v89, v49
    v_add_f32 v90, v90, v50
    v_add_f32 v91, v91, v51
    v_add_f32 v92, v92, v52
    v_add_f32 v93, v93, v53
    v_add_f32 v94, v94, v54
    v_add_f32 v95, v95, v55
    v_add_f32 v96, v96, v56
    v_add_f32 v97, v97, v57
    v_add_f32 v98, v98, v58
    v_add_f32 v99, v99, v59
    v_add_f32 v100, v100, v60
    v_add_f32 v101, v101, v61
    v_add_f32 v102, v102, v62
    v_add_f32 v103, v103, v63
    v_add_f32 v104, v104, v64
    v_add_f32 v105, v105, v65
    v_add_f32 v106, v106, v66
    v_add_f32 v107, v107, v67
    v_and_b32 v3, 31, v1
    v_lshrrev_b32 v4, 5, v1
    v_lshlrev_b32 v3, 4, v3
    v_lshlrev_b32 v4, 3, v4
    v_add_u32 v3, v3, v4
    s_lshl_b32 s33, s28, 2
    s_add_u32 s33, s33, s29
    s_mul_i32 s33, s33, 10240
    s_lshl_b32 s34, s21, 9
    s_add_u32 s33, s33, s34
    v_cvt_pk_bf16_f32 v8, v88, v89
    v_cvt_pk_bf16_f32 v9, v90, v91
    buffer_store_dwordx2 v[8:9], v3, s[68:71], s33 offen sc0 sc1
    s_add_u32 s33, s33, 2048
    v_cvt_pk_bf16_f32 v10, v92, v93
    v_cvt_pk_bf16_f32 v11, v94, v95
    buffer_store_dwordx2 v[10:11], v3, s[68:71], s33 offen sc0 sc1
    s_add_u32 s33, s33, 2048
    v_cvt_pk_bf16_f32 v12, v96, v97
    v_cvt_pk_bf16_f32 v13, v98, v99
    buffer_store_dwordx2 v[12:13], v3, s[68:71], s33 offen sc0 sc1
    s_add_u32 s33, s33, 2048
    v_cvt_pk_bf16_f32 v14, v100, v101
    v_cvt_pk_bf16_f32 v15, v102, v103
    buffer_store_dwordx2 v[14:15], v3, s[68:71], s33 offen sc0 sc1
    s_add_u32 s33, s33, 2048
    v_cvt_pk_bf16_f32 v16, v104, v105
    v_cvt_pk_bf16_f32 v17, v106, v107
    buffer_store_dwordx2 v[16:17], v3, s[68:71], s33 offen sc0 sc1
    s_add_u32 s33, s33, 2048
    s_barrier
    s_endpgm
L_attn_kernel_end:
    s_endpgm
.globl outp_kernel
.p2align 8
.type outp_kernel,@function
outp_kernel:
    s_cmp_ge_u32 s2, 256
    s_cbranch_scc1 L_outp_kernel_end
    s_load_dwordx2 s[4:5], s[0:1], 72
    s_load_dwordx2 s[6:7], s[0:1], 0
    s_load_dwordx2 s[24:25], s[0:1], 56
    v_and_b32 v1, 63, v0
    v_lshrrev_b32 v2, 6, v0
    s_and_b32 s3, s2, 7
    s_lshr_b32 s20, s2, 3
    s_lshr_b32 s21, s3, 1
    s_lshl_b32 s21, s21, 4
    s_lshr_b32 s22, s20, 1
    s_add_u32 s21, s21, s22
    s_and_b32 s22, s3, 1
    s_lshl_b32 s22, s22, 1
    s_and_b32 s23, s20, 1
    s_add_u32 s22, s22, s23
    v_readfirstlane_b32 s20, v2
    v_lshlrev_b32 v9, 4, v1
    s_mul_i32 s26, s22, 757760
    v_add_u32 v4, s26, v9
    v_add_u32 v5, 151552, v4
    v_add_u32 v6, 303104, v4
    v_add_u32 v7, 454656, v4
    v_add_u32 v8, 606208, v4
    s_waitcnt lgkmcnt(0)
    s_add_u32 s8, s4, 7864320
    s_addc_u32 s9, s5, 0
    s_mov_b32 s10, 9699328
    s_mov_b32 s11, 0x20000
    s_add_u32 s12, s4, 17563648
    s_addc_u32 s13, s5, 0
    s_mov_b32 s14, 3031040
    s_mov_b32 s15, 0x20000
    s_lshl_b32 s27, s20, 10
    s_mul_i32 s28, s21, 110592
    s_add_u32 s28, s28, s27
    s_mul_i32 s29, s21, 40960
    s_add_u32 s29, s29, s27
    s_add_u32 s29, s29, 7077888
    s_add_u32 s30, s27, 110592
    v_mov_b32 v11, 0x7ff00000
    buffer_load_dwordx4 v[100:103], v9, s[8:11], s29 offen
    buffer_load_dwordx4 v[104:107], v4, s[12:15], s30 offen
    buffer_load_dwordx4 v[108:111], v5, s[12:15], s30 offen
    buffer_load_dwordx4 v[112:115], v6, s[12:15], s30 offen
    buffer_load_dwordx4 v[116:119], v7, s[12:15], s30 offen
    buffer_load_dwordx4 v[120:123], v8, s[12:15], s30 offen
    s_add_u32 s29, s29, 4096
    s_add_u32 s30, s30, 4096
    buffer_load_dwordx4 v[124:127], v9, s[8:11], s29 offen
    buffer_load_dwordx4 v[128:131], v4, s[12:15], s30 offen
    buffer_load_dwordx4 v[132:135], v5, s[12:15], s30 offen
    buffer_load_dwordx4 v[136:139], v6, s[12:15], s30 offen
    buffer_load_dwordx4 v[140:143], v7, s[12:15], s30 offen
    buffer_load_dwordx4 v[144:147], v8, s[12:15], s30 offen
    s_add_u32 s29, s29, 4096
    s_add_u32 s30, s30, 4096
    buffer_load_dwordx4 v[148:151], v9, s[8:11], s29 offen
    buffer_load_dwordx4 v[152:155], v4, s[12:15], s30 offen
    buffer_load_dwordx4 v[156:159], v5, s[12:15], s30 offen
    buffer_load_dwordx4 v[160:163], v6, s[12:15], s30 offen
    buffer_load_dwordx4 v[164:167], v7, s[12:15], s30 offen
    buffer_load_dwordx4 v[168:171], v8, s[12:15], s30 offen
    s_add_u32 s29, s29, 4096
    s_add_u32 s30, s30, 4096
    buffer_load_dwordx4 v[172:175], v9, s[8:11], s29 offen
    buffer_load_dwordx4 v[176:179], v4, s[12:15], s30 offen
    buffer_load_dwordx4 v[180:183], v5, s[12:15], s30 offen
    buffer_load_dwordx4 v[184:187], v6, s[12:15], s30 offen
    buffer_load_dwordx4 v[188:191], v7, s[12:15], s30 offen
    buffer_load_dwordx4 v[192:195], v8, s[12:15], s30 offen
    s_add_u32 s29, s29, 4096
    s_add_u32 s30, s30, 4096
    buffer_load_dwordx4 v[196:199], v9, s[8:11], s29 offen
    buffer_load_dwordx4 v[200:203], v4, s[12:15], s30 offen
    buffer_load_dwordx4 v[204:207], v5, s[12:15], s30 offen
    buffer_load_dwordx4 v[208:211], v6, s[12:15], s30 offen
    buffer_load_dwordx4 v[212:215], v7, s[12:15], s30 offen
    buffer_load_dwordx4 v[216:219], v8, s[12:15], s30 offen
    s_add_u32 s29, s29, 4096
    s_add_u32 s30, s30, 4096
    buffer_load_dwordx4 a[0:3], v9, s[8:11], s29 offen
    buffer_load_dwordx4 a[4:7], v4, s[12:15], s30 offen
    buffer_load_dwordx4 a[8:11], v5, s[12:15], s30 offen
    buffer_load_dwordx4 a[12:15], v6, s[12:15], s30 offen
    buffer_load_dwordx4 a[16:19], v7, s[12:15], s30 offen
    buffer_load_dwordx4 a[20:23], v8, s[12:15], s30 offen
    s_add_u32 s29, s29, 4096
    s_add_u32 s30, s30, 4096
    buffer_load_dwordx4 a[24:27], v9, s[8:11], s29 offen
    buffer_load_dwordx4 a[28:31], v4, s[12:15], s30 offen
    buffer_load_dwordx4 a[32:35], v5, s[12:15], s30 offen
    buffer_load_dwordx4 a[36:39], v6, s[12:15], s30 offen
    buffer_load_dwordx4 a[40:43], v7, s[12:15], s30 offen
    buffer_load_dwordx4 a[44:47], v8, s[12:15], s30 offen
    s_add_u32 s29, s29, 4096
    s_add_u32 s30, s30, 4096
    buffer_load_dwordx4 a[48:51], v9, s[8:11], s29 offen
    buffer_load_dwordx4 a[52:55], v4, s[12:15], s30 offen
    buffer_load_dwordx4 a[56:59], v5, s[12:15], s30 offen
    buffer_load_dwordx4 a[60:63], v6, s[12:15], s30 offen
    buffer_load_dwordx4 a[64:67], v7, s[12:15], s30 offen
    buffer_load_dwordx4 a[68:71], v8, s[12:15], s30 offen
    s_add_u32 s29, s29, 4096
    s_add_u32 s30, s30, 4096
    buffer_load_dwordx4 a[72:75], v9, s[8:11], s29 offen
    buffer_load_dwordx4 a[76:79], v4, s[12:15], s30 offen
    buffer_load_dwordx4 a[80:83], v5, s[12:15], s30 offen
    buffer_load_dwordx4 a[84:87], v6, s[12:15], s30 offen
    buffer_load_dwordx4 a[88:91], v7, s[12:15], s30 offen
    buffer_load_dwordx4 a[92:95], v8, s[12:15], s30 offen
    s_add_u32 s29, s29, 4096
    s_add_u32 s30, s30, 4096
    buffer_load_dwordx4 a[96:99], v9, s[8:11], s29 offen
    buffer_load_dwordx4 a[100:103], v4, s[12:15], s30 offen
    buffer_load_dwordx4 a[104:107], v5, s[12:15], s30 offen
    buffer_load_dwordx4 a[108:111], v6, s[12:15], s30 offen
    buffer_load_dwordx4 a[112:115], v7, s[12:15], s30 offen
    buffer_load_dwordx4 a[116:119], v8, s[12:15], s30 offen
    s_add_u32 s29, s29, 4096
    s_add_u32 s30, s30, 4096
    v_lshrrev_b32 v10, 3, v0
    v_and_b32 v11, 7, v0
    s_lshl_b32 s31, s21, 5
    v_add_u32 v12, s31, v10
    v_mul_u32_u24 v13, 640, v12
    s_mul_i32 s32, s22, 160
    v_lshlrev_b32 v14, 3, v11
    v_add3_u32 v13, v13, s32, v14
    v_cmp_gt_u32 vcc, 4, v11
    s_mov_b64 s[34:35], vcc
    s_mov_b32 s16, s6
    s_mov_b32 s17, s7
    s_mov_b32 s18, 2621440
    s_mov_b32 s19, 0x20000
    v_lshlrev_b32 v14, 1, v13
    s_add_u32 s36, s4, 20594688
    s_addc_u32 s37, s5, 0
    s_mov_b32 s38, 2621440
    s_mov_b32 s39, 0x20000
    s_lshl_b32 s44, s21, 2
    s_add_u32 s44, s44, s22
    s_mul_i32 s44, s44, 10240
    s_add_u32 s45, s44, 4096
    s_add_u32 s46, s44, 8192
    v_lshlrev_b32 v3, 9, v11
    v_lshlrev_b32 v2, 4, v10
    v_add_u32 v3, v3, v2
    v_mov_b32 v20, 0
    v_mov_b32 v21, 0
    v_mov_b32 v22, 0
    v_mov_b32 v23, 0
    v_mov_b32 v24, 0
    v_mov_b32 v25, 0
    v_mov_b32 v26, 0
    v_mov_b32 v27, 0
    v_mov_b32 v28, 0
    v_mov_b32 v29, 0
    v_mov_b32 v30, 0
    v_mov_b32 v31, 0
    v_mov_b32 v32, 0
    v_mov_b32 v33, 0
    v_mov_b32 v34, 0
    v_mov_b32 v35, 0
    v_mov_b32 v36, 0
    v_mov_b32 v37, 0
    v_mov_b32 v38, 0
    v_mov_b32 v39, 0
    v_mov_b32 v40, 0
    v_mov_b32 v41, 0
    v_mov_b32 v42, 0
    v_mov_b32 v43, 0
    v_mov_b32 v44, 0
    v_mov_b32 v45, 0
    v_mov_b32 v46, 0
    v_mov_b32 v47, 0
    v_mov_b32 v48, 0
    v_mov_b32 v49, 0
    v_mov_b32 v50, 0
    v_mov_b32 v51, 0
    v_mov_b32 v52, 0
    v_mov_b32 v53, 0
    v_mov_b32 v54, 0
    v_mov_b32 v55, 0
    v_mov_b32 v56, 0
    v_mov_b32 v57, 0
    v_mov_b32 v58, 0
    v_mov_b32 v59, 0
    v_mov_b32 v60, 0
    v_mov_b32 v61, 0
    v_mov_b32 v62, 0
    v_mov_b32 v63, 0
    v_mov_b32 v64, 0
    v_mov_b32 v65, 0
    v_mov_b32 v66, 0
    v_mov_b32 v67, 0
    v_mov_b32 v68, 0
    v_mov_b32 v69, 0
    v_mov_b32 v70, 0
    v_mov_b32 v71, 0
    v_mov_b32 v72, 0
    v_mov_b32 v73, 0
    v_mov_b32 v74, 0
    v_mov_b32 v75, 0
    v_mov_b32 v76, 0
    v_mov_b32 v77, 0
    v_mov_b32 v78, 0
    v_mov_b32 v79, 0
    v_mov_b32 v80, 0
    v_mov_b32 v81, 0
    v_mov_b32 v82, 0
    v_mov_b32 v83, 0
    v_mov_b32 v84, 0
    v_mov_b32 v85, 0
    v_mov_b32 v86, 0
    v_mov_b32 v87, 0
    v_mov_b32 v88, 0
    v_mov_b32 v89, 0
    v_mov_b32 v90, 0
    v_mov_b32 v91, 0
    v_mov_b32 v92, 0
    v_mov_b32 v93, 0
    v_mov_b32 v94, 0
    v_mov_b32 v95, 0
    v_mov_b32 v96, 0
    v_mov_b32 v97, 0
    v_mov_b32 v98, 0
    v_mov_b32 v99, 0
    s_waitcnt vmcnt(54)
    v_mfma_f32_32x32x16_bf16 v[20:35], v[104:107], v[100:103], v[20:35]
    v_mfma_f32_32x32x16_bf16 v[36:51], v[108:111], v[100:103], v[36:51]
    v_mfma_f32_32x32x16_bf16 v[52:67], v[112:115], v[100:103], v[52:67]
    v_mfma_f32_32x32x16_bf16 v[68:83], v[116:119], v[100:103], v[68:83]
    v_mfma_f32_32x32x16_bf16 v[84:99], v[120:123], v[100:103], v[84:99]
    buffer_load_dwordx4 v[220:223], v14, s[16:19], 0 offen offset:0
    buffer_load_dwordx4 v[232:235], v3, s[36:39], s44 offen
    buffer_load_dwordx4 v[224:227], v14, s[16:19], 0 offen offset:128
    buffer_load_dwordx4 v[236:239], v3, s[36:39], s45 offen
    s_mov_b64 exec, s[34:35]
    buffer_load_dwordx4 v[228:231], v14, s[16:19], 0 offen offset:256
    buffer_load_dwordx4 v[240:243], v3, s[36:39], s46 offen
    s_mov_b64 exec, -1
    s_waitcnt vmcnt(54)
    v_mfma_f32_32x32x16_bf16 v[20:35], v[128:131], v[124:127], v[20:35]
    v_mfma_f32_32x32x16_bf16 v[36:51], v[132:135], v[124:127], v[36:51]
    v_mfma_f32_32x32x16_bf16 v[52:67], v[136:139], v[124:127], v[52:67]
    v_mfma_f32_32x32x16_bf16 v[68:83], v[140:143], v[124:127], v[68:83]
    v_mfma_f32_32x32x16_bf16 v[84:99], v[144:147], v[124:127], v[84:99]
    s_waitcnt vmcnt(48)
    v_mfma_f32_32x32x16_bf16 v[20:35], v[152:155], v[148:151], v[20:35]
    v_mfma_f32_32x32x16_bf16 v[36:51], v[156:159], v[148:151], v[36:51]
    v_mfma_f32_32x32x16_bf16 v[52:67], v[160:163], v[148:151], v[52:67]
    v_mfma_f32_32x32x16_bf16 v[68:83], v[164:167], v[148:151], v[68:83]
    v_mfma_f32_32x32x16_bf16 v[84:99], v[168:171], v[148:151], v[84:99]
    s_waitcnt vmcnt(42)
    v_mfma_f32_32x32x16_bf16 v[20:35], v[176:179], v[172:175], v[20:35]
    v_mfma_f32_32x32x16_bf16 v[36:51], v[180:183], v[172:175], v[36:51]
    v_mfma_f32_32x32x16_bf16 v[52:67], v[184:187], v[172:175], v[52:67]
    v_mfma_f32_32x32x16_bf16 v[68:83], v[188:191], v[172:175], v[68:83]
    v_mfma_f32_32x32x16_bf16 v[84:99], v[192:195], v[172:175], v[84:99]
    s_waitcnt vmcnt(36)
    v_mfma_f32_32x32x16_bf16 v[20:35], v[200:203], v[196:199], v[20:35]
    v_mfma_f32_32x32x16_bf16 v[36:51], v[204:207], v[196:199], v[36:51]
    v_mfma_f32_32x32x16_bf16 v[52:67], v[208:211], v[196:199], v[52:67]
    v_mfma_f32_32x32x16_bf16 v[68:83], v[212:215], v[196:199], v[68:83]
    v_mfma_f32_32x32x16_bf16 v[84:99], v[216:219], v[196:199], v[84:99]
    s_waitcnt vmcnt(30)
    v_mfma_f32_32x32x16_bf16 v[20:35], a[4:7], a[0:3], v[20:35]
    v_mfma_f32_32x32x16_bf16 v[36:51], a[8:11], a[0:3], v[36:51]
    v_mfma_f32_32x32x16_bf16 v[52:67], a[12:15], a[0:3], v[52:67]
    v_mfma_f32_32x32x16_bf16 v[68:83], a[16:19], a[0:3], v[68:83]
    v_mfma_f32_32x32x16_bf16 v[84:99], a[20:23], a[0:3], v[84:99]
    s_waitcnt vmcnt(24)
    v_mfma_f32_32x32x16_bf16 v[20:35], a[28:31], a[24:27], v[20:35]
    v_mfma_f32_32x32x16_bf16 v[36:51], a[32:35], a[24:27], v[36:51]
    v_mfma_f32_32x32x16_bf16 v[52:67], a[36:39], a[24:27], v[52:67]
    v_mfma_f32_32x32x16_bf16 v[68:83], a[40:43], a[24:27], v[68:83]
    v_mfma_f32_32x32x16_bf16 v[84:99], a[44:47], a[24:27], v[84:99]
    s_waitcnt vmcnt(18)
    v_mfma_f32_32x32x16_bf16 v[20:35], a[52:55], a[48:51], v[20:35]
    v_mfma_f32_32x32x16_bf16 v[36:51], a[56:59], a[48:51], v[36:51]
    v_mfma_f32_32x32x16_bf16 v[52:67], a[60:63], a[48:51], v[52:67]
    v_mfma_f32_32x32x16_bf16 v[68:83], a[64:67], a[48:51], v[68:83]
    v_mfma_f32_32x32x16_bf16 v[84:99], a[68:71], a[48:51], v[84:99]
    s_waitcnt vmcnt(12)
    v_mfma_f32_32x32x16_bf16 v[20:35], a[76:79], a[72:75], v[20:35]
    v_mfma_f32_32x32x16_bf16 v[36:51], a[80:83], a[72:75], v[36:51]
    v_mfma_f32_32x32x16_bf16 v[52:67], a[84:87], a[72:75], v[52:67]
    v_mfma_f32_32x32x16_bf16 v[68:83], a[88:91], a[72:75], v[68:83]
    v_mfma_f32_32x32x16_bf16 v[84:99], a[92:95], a[72:75], v[84:99]
    s_waitcnt vmcnt(6)
    v_mfma_f32_32x32x16_bf16 v[20:35], a[100:103], a[96:99], v[20:35]
    v_mfma_f32_32x32x16_bf16 v[36:51], a[104:107], a[96:99], v[36:51]
    v_mfma_f32_32x32x16_bf16 v[52:67], a[108:111], a[96:99], v[52:67]
    v_mfma_f32_32x32x16_bf16 v[68:83], a[112:115], a[96:99], v[68:83]
    v_mfma_f32_32x32x16_bf16 v[84:99], a[116:119], a[96:99], v[84:99]
    s_waitcnt vmcnt(0)
    v_and_b32 v15, 31, v1
    v_lshrrev_b32 v16, 5, v1
    v_mul_u32_u24 v15, 656, v15
    v_lshlrev_b32 v16, 4, v16
    s_mul_i32 s33, s20, 20992
    v_add3_u32 v15, v15, v16, s33
    s_nop 0
    ds_write_b128 v15, v[20:23] offset:0
    ds_write_b128 v15, v[24:27] offset:32
    ds_write_b128 v15, v[28:31] offset:64
    ds_write_b128 v15, v[32:35] offset:96
    ds_write_b128 v15, v[36:39] offset:128
    ds_write_b128 v15, v[40:43] offset:160
    ds_write_b128 v15, v[44:47] offset:192
    ds_write_b128 v15, v[48:51] offset:224
    ds_write_b128 v15, v[52:55] offset:256
    ds_write_b128 v15, v[56:59] offset:288
    ds_write_b128 v15, v[60:63] offset:320
    ds_write_b128 v15, v[64:67] offset:352
    ds_write_b128 v15, v[68:71] offset:384
    ds_write_b128 v15, v[72:75] offset:416
    ds_write_b128 v15, v[76:79] offset:448
    ds_write_b128 v15, v[80:83] offset:480
    ds_write_b128 v15, v[84:87] offset:512
    ds_write_b128 v15, v[88:91] offset:544
    ds_write_b128 v15, v[92:95] offset:576
    ds_write_b128 v15, v[96:99] offset:608
    v_mul_u32_u24 v15, 656, v10
    v_lshlrev_b32 v16, 5, v11
    v_add_u32 v15, v15, v16
    v_lshlrev_b32 v14, 1, v13
    s_mov_b32 s16, s24
    s_mov_b32 s17, s25
    s_mov_b32 s18, 2621440
    s_mov_b32 s19, 0x20000
    s_waitcnt lgkmcnt(0)
    s_barrier
    ds_read_b128 v[100:103], v15 offset:0
    ds_read_b128 v[104:107], v15 offset:16
    ds_read_b128 v[108:111], v15 offset:20992
    ds_read_b128 v[112:115], v15 offset:21008
    ds_read_b128 v[116:119], v15 offset:41984
    ds_read_b128 v[120:123], v15 offset:42000
    ds_read_b128 v[124:127], v15 offset:62976
    ds_read_b128 v[128:131], v15 offset:62992
    ds_read_b128 v[132:135], v15 offset:256
    ds_read_b128 v[136:139], v15 offset:272
    ds_read_b128 v[140:143], v15 offset:21248
    ds_read_b128 v[144:147], v15 offset:21264
    ds_read_b128 v[148:151], v15 offset:42240
    ds_read_b128 v[152:155], v15 offset:42256
    ds_read_b128 v[156:159], v15 offset:63232
    ds_read_b128 v[160:163], v15 offset:63248
    s_waitcnt lgkmcnt(8)
    s_mov_b64 exec, s[34:35]
    ds_read_b128 v[164:167], v15 offset:512
    ds_read_b128 v[168:171], v15 offset:528
    ds_read_b128 v[172:175], v15 offset:21504
    ds_read_b128 v[176:179], v15 offset:21520
    ds_read_b128 v[180:183], v15 offset:42496
    ds_read_b128 v[184:187], v15 offset:42512
    ds_read_b128 v[188:191], v15 offset:63488
    ds_read_b128 v[192:195], v15 offset:63504
    s_mov_b64 exec, -1
    v_add_f32 v100, v100, v108
    v_add_f32 v116, v116, v124
    v_add_f32 v101, v101, v109
    v_add_f32 v117, v117, v125
    v_add_f32 v102, v102, v110
    v_add_f32 v118, v118, v126
    v_add_f32 v103, v103, v111
    v_add_f32 v119, v119, v127
    v_add_f32 v104, v104, v112
    v_add_f32 v120, v120, v128
    v_add_f32 v105, v105, v113
    v_add_f32 v121, v121, v129
    v_add_f32 v106, v106, v114
    v_add_f32 v122, v122, v130
    v_add_f32 v107, v107, v115
    v_add_f32 v123, v123, v131
    v_add_f32 v100, v100, v116
    v_add_f32 v101, v101, v117
    v_add_f32 v102, v102, v118
    v_add_f32 v103, v103, v119
    v_add_f32 v104, v104, v120
    v_add_f32 v105, v105, v121
    v_add_f32 v106, v106, v122
    v_add_f32 v107, v107, v123
    v_lshlrev_b32 v108, 16, v220
    v_and_b32 v109, 0xffff0000, v220
    v_lshlrev_b32 v110, 16, v221
    v_and_b32 v111, 0xffff0000, v221
    v_lshlrev_b32 v112, 16, v222
    v_and_b32 v113, 0xffff0000, v222
    v_lshlrev_b32 v114, 16, v223
    v_and_b32 v115, 0xffff0000, v223
    v_add_f32 v100, v100, v108
    v_add_f32 v101, v101, v109
    v_add_f32 v102, v102, v110
    v_add_f32 v103, v103, v111
    v_add_f32 v104, v104, v112
    v_add_f32 v105, v105, v113
    v_add_f32 v106, v106, v114
    v_add_f32 v107, v107, v115
    v_lshlrev_b32 v108, 16, v232
    v_and_b32 v109, 0xffff0000, v232
    v_lshlrev_b32 v110, 16, v233
    v_and_b32 v111, 0xffff0000, v233
    v_lshlrev_b32 v112, 16, v234
    v_and_b32 v113, 0xffff0000, v234
    v_lshlrev_b32 v114, 16, v235
    v_and_b32 v115, 0xffff0000, v235
    v_add_f32 v100, v100, v108
    v_add_f32 v101, v101, v109
    v_add_f32 v102, v102, v110
    v_add_f32 v103, v103, v111
    v_add_f32 v104, v104, v112
    v_add_f32 v105, v105, v113
    v_add_f32 v106, v106, v114
    v_add_f32 v107, v107, v115
    v_cvt_pk_bf16_f32 v108, v100, v101
    v_cvt_pk_bf16_f32 v109, v102, v103
    v_cvt_pk_bf16_f32 v110, v104, v105
    v_cvt_pk_bf16_f32 v111, v106, v107
    buffer_store_dwordx4 v[108:111], v14, s[16:19], 0 offen offset:0 sc0 sc1
    s_waitcnt lgkmcnt(8)
    v_add_f32 v132, v132, v140
    v_add_f32 v148, v148, v156
    v_add_f32 v133, v133, v141
    v_add_f32 v149, v149, v157
    v_add_f32 v134, v134, v142
    v_add_f32 v150, v150, v158
    v_add_f32 v135, v135, v143
    v_add_f32 v151, v151, v159
    v_add_f32 v136, v136, v144
    v_add_f32 v152, v152, v160
    v_add_f32 v137, v137, v145
    v_add_f32 v153, v153, v161
    v_add_f32 v138, v138, v146
    v_add_f32 v154, v154, v162
    v_add_f32 v139, v139, v147
    v_add_f32 v155, v155, v163
    v_add_f32 v132, v132, v148
    v_add_f32 v133, v133, v149
    v_add_f32 v134, v134, v150
    v_add_f32 v135, v135, v151
    v_add_f32 v136, v136, v152
    v_add_f32 v137, v137, v153
    v_add_f32 v138, v138, v154
    v_add_f32 v139, v139, v155
    v_lshlrev_b32 v140, 16, v224
    v_and_b32 v141, 0xffff0000, v224
    v_lshlrev_b32 v142, 16, v225
    v_and_b32 v143, 0xffff0000, v225
    v_lshlrev_b32 v144, 16, v226
    v_and_b32 v145, 0xffff0000, v226
    v_lshlrev_b32 v146, 16, v227
    v_and_b32 v147, 0xffff0000, v227
    v_add_f32 v132, v132, v140
    v_add_f32 v133, v133, v141
    v_add_f32 v134, v134, v142
    v_add_f32 v135, v135, v143
    v_add_f32 v136, v136, v144
    v_add_f32 v137, v137, v145
    v_add_f32 v138, v138, v146
    v_add_f32 v139, v139, v147
    v_lshlrev_b32 v140, 16, v236
    v_and_b32 v141, 0xffff0000, v236
    v_lshlrev_b32 v142, 16, v237
    v_and_b32 v143, 0xffff0000, v237
    v_lshlrev_b32 v144, 16, v238
    v_and_b32 v145, 0xffff0000, v238
    v_lshlrev_b32 v146, 16, v239
    v_and_b32 v147, 0xffff0000, v239
    v_add_f32 v132, v132, v140
    v_add_f32 v133, v133, v141
    v_add_f32 v134, v134, v142
    v_add_f32 v135, v135, v143
    v_add_f32 v136, v136, v144
    v_add_f32 v137, v137, v145
    v_add_f32 v138, v138, v146
    v_add_f32 v139, v139, v147
    v_cvt_pk_bf16_f32 v140, v132, v133
    v_cvt_pk_bf16_f32 v141, v134, v135
    v_cvt_pk_bf16_f32 v142, v136, v137
    v_cvt_pk_bf16_f32 v143, v138, v139
    buffer_store_dwordx4 v[140:143], v14, s[16:19], 0 offen offset:128 sc0 sc1
    s_waitcnt lgkmcnt(0)
    v_add_f32 v164, v164, v172
    v_add_f32 v180, v180, v188
    v_add_f32 v165, v165, v173
    v_add_f32 v181, v181, v189
    v_add_f32 v166, v166, v174
    v_add_f32 v182, v182, v190
    v_add_f32 v167, v167, v175
    v_add_f32 v183, v183, v191
    v_add_f32 v168, v168, v176
    v_add_f32 v184, v184, v192
    v_add_f32 v169, v169, v177
    v_add_f32 v185, v185, v193
    v_add_f32 v170, v170, v178
    v_add_f32 v186, v186, v194
    v_add_f32 v171, v171, v179
    v_add_f32 v187, v187, v195
    v_add_f32 v164, v164, v180
    v_add_f32 v165, v165, v181
    v_add_f32 v166, v166, v182
    v_add_f32 v167, v167, v183
    v_add_f32 v168, v168, v184
    v_add_f32 v169, v169, v185
    v_add_f32 v170, v170, v186
    v_add_f32 v171, v171, v187
    v_lshlrev_b32 v172, 16, v228
    v_and_b32 v173, 0xffff0000, v228
    v_lshlrev_b32 v174, 16, v229
    v_and_b32 v175, 0xffff0000, v229
    v_lshlrev_b32 v176, 16, v230
    v_and_b32 v177, 0xffff0000, v230
    v_lshlrev_b32 v178, 16, v231
    v_and_b32 v179, 0xffff0000, v231
    v_add_f32 v164, v164, v172
    v_add_f32 v165, v165, v173
    v_add_f32 v166, v166, v174
    v_add_f32 v167, v167, v175
    v_add_f32 v168, v168, v176
    v_add_f32 v169, v169, v177
    v_add_f32 v170, v170, v178
    v_add_f32 v171, v171, v179
    v_lshlrev_b32 v172, 16, v240
    v_and_b32 v173, 0xffff0000, v240
    v_lshlrev_b32 v174, 16, v241
    v_and_b32 v175, 0xffff0000, v241
    v_lshlrev_b32 v176, 16, v242
    v_and_b32 v177, 0xffff0000, v242
    v_lshlrev_b32 v178, 16, v243
    v_and_b32 v179, 0xffff0000, v243
    v_add_f32 v164, v164, v172
    v_add_f32 v165, v165, v173
    v_add_f32 v166, v166, v174
    v_add_f32 v167, v167, v175
    v_add_f32 v168, v168, v176
    v_add_f32 v169, v169, v177
    v_add_f32 v170, v170, v178
    v_add_f32 v171, v171, v179
    v_cvt_pk_bf16_f32 v172, v164, v165
    v_cvt_pk_bf16_f32 v173, v166, v167
    v_cvt_pk_bf16_f32 v174, v168, v169
    v_cvt_pk_bf16_f32 v175, v170, v171
    s_mov_b64 exec, s[34:35]
    buffer_store_dwordx4 v[172:175], v14, s[16:19], 0 offen offset:256 sc0 sc1
L_outp_kernel_end:
    s_endpgm
.section .rodata,"a"
.p2align 6
.amdhsa_kernel parallel_sum__mha_block__glu_gated_bilinear__prompt_kernel
  .amdhsa_next_free_vgpr 256
  .amdhsa_next_free_sgpr 102
  .amdhsa_accum_offset 256
  .amdhsa_group_segment_fixed_size 0
  .amdhsa_kernarg_size 80
  .amdhsa_user_sgpr_count 2
  .amdhsa_user_sgpr_kernarg_segment_ptr 1
  .amdhsa_system_sgpr_workgroup_id_x 1
.end_amdhsa_kernel
.p2align 6
.amdhsa_kernel attn_kernel
  .amdhsa_next_free_vgpr 168
  .amdhsa_next_free_sgpr 102
  .amdhsa_accum_offset 168
  .amdhsa_group_segment_fixed_size 0
  .amdhsa_kernarg_size 80
  .amdhsa_user_sgpr_count 2
  .amdhsa_user_sgpr_kernarg_segment_ptr 1
  .amdhsa_system_sgpr_workgroup_id_x 1
.end_amdhsa_kernel
.p2align 6
.amdhsa_kernel outp_kernel
  .amdhsa_next_free_vgpr 376
  .amdhsa_next_free_sgpr 102
  .amdhsa_accum_offset 256
  .amdhsa_group_segment_fixed_size 0
  .amdhsa_kernarg_size 80
  .amdhsa_user_sgpr_count 2
  .amdhsa_user_sgpr_kernarg_segment_ptr 1
  .amdhsa_system_sgpr_workgroup_id_x 1
.end_amdhsa_kernel
```
